```python
import torch

def _softmax(x, axis=-1):
    return torch.softmax(x, dim=axis)
def _gelu(x):
    return torch.nn.functional.gelu(x, approximate="tanh")
def _silu(x):
    return torch.nn.functional.silu(x)
def _sigmoid(x):
    return torch.sigmoid(x)
def _layernorm(x, axis=-1, eps=1e-5):
    m = x.mean(dim=axis, keepdim=True)
    v = x.var(dim=axis, keepdim=True, unbiased=False)
    return (x - m) / torch.sqrt(v + eps)
def _scatter_add(tgt, idx, src, axis=0):
    return tgt.clone().index_add_(axis, idx, src)
def _segment_sum(src, seg, n):
    out = torch.zeros((n,) + src.shape[1:], dtype=src.dtype)
    return out.index_add_(0, seg, src)
def _pad(x, pw):
    flat = tuple(v for pair in reversed(pw) for v in pair)
    return torch.nn.functional.pad(x, flat)

kernel_name = 'parallel_sum__mha_block_cached__geglu_ffn__decode'

def setup_inputs():

    _w = (lambda a: (lambda t: t.to(torch.bfloat16) if t.is_floating_point() else t)(torch.as_tensor(a)))
    def _A_setup():
        B, Sq, D = 1, 1, 1024
        H, Sk, Dh = 32, 32768, 128
        return {
            "x": _w((lambda *s: torch.randn(*s, dtype=torch.bfloat16) * 0.05)(B, Sq, D)),
            "k_cache": _w((lambda *s: torch.randn(*s, dtype=torch.bfloat16) * 3.2)(B, H, Sk, Dh)),
            "v_cache": _w((lambda *s: torch.randn(*s, dtype=torch.bfloat16) * 1.6)(B, H, Sk, Dh)),
            "wq": _w((lambda *s: torch.randn(*s, dtype=torch.bfloat16) * 3.2)(D, H * Dh) * (D ** -0.5)),
            "wo": _w((lambda *s: torch.randn(*s, dtype=torch.bfloat16) * 1.6)(H * Dh, D) * ((H * Dh) ** -0.5)),
        }
    _A_in = _A_setup()

    def _B_setup():
        B, S, D, F = 1, 1, 1024, 3584
        return {
            "x": _w((lambda *s: torch.randn(*s, dtype=torch.bfloat16) * 0.05)(B, S, D)),
            "w_gate": _w((lambda *s: torch.randn(*s, dtype=torch.bfloat16) * 0.05)(D, F)),
            "w_up": _w((lambda *s: torch.randn(*s, dtype=torch.bfloat16) * 0.05)(D, F)),
            "w_down": _w((lambda *s: torch.randn(*s, dtype=torch.bfloat16) * 0.05)(F, D)),
        }
    _B_in = _B_setup()

    return {
        "A_x": _A_in["x"],
        "A_k_cache": _A_in["k_cache"],
        "A_v_cache": _A_in["v_cache"],
        "A_wq": _A_in["wq"],
        "A_wo": _A_in["wo"],
        "B_x": _B_in["x"],
        "B_w_gate": _B_in["w_gate"],
        "B_w_up": _B_in["w_up"],
        "B_w_down": _B_in["w_down"],
    }

def reference(A_x, A_k_cache, A_v_cache, A_wq, A_wo, B_x, B_w_gate, B_w_up, B_w_down):
    def _A_ref(x, k_cache, v_cache, wq, wo):
        B, Sq, D = x.shape
        H, Dh = 32, 128
        q = (lambda x, *d: x.permute(*d))((x @ wq).reshape(B, Sq, H, Dh), 0, 2, 1, 3)
        scores = torch.einsum("bhqd,bhkd->bhqk", q, k_cache) * (Dh ** -0.5)
        p = _softmax(scores, axis=-1)
        o = torch.einsum("bhqk,bhkd->bhqd", p, v_cache)
        return (lambda x, *d: x.permute(*d))(o, 0, 2, 1, 3).reshape(B, Sq, H * Dh) @ wo

    def _B_ref(x, w_gate, w_up, w_down):
        return (_gelu(x @ w_gate) * (x @ w_up)) @ w_down

    x = A_x
    xn = _layernorm(x, axis=-1)
    return x + _A_ref(xn, A_k_cache, A_v_cache, A_wq, A_wo) + _B_ref(xn, B_w_gate, B_w_up, B_w_down)
```

```asm
; @launch grid=(256,1,1) block=(448,1,1) lds=48128
.amdgcn_target "amdgcn-amd-amdhsa--gfx950"
.text
.globl parallel_sum__mha_block_cached__geglu_ffn__decode_kernel
.p2align 8
.type parallel_sum__mha_block_cached__geglu_ffn__decode_kernel,@function
parallel_sum__mha_block_cached__geglu_ffn__decode_kernel:
    s_cmp_ge_u32 s2, 256
    s_cbranch_scc1 L_end
    s_load_dwordx16 s[4:19], s[0:1], 0
    s_load_dwordx8 s[20:27], s[0:1], 64
    v_lshrrev_b32 v1, 6, v0
    v_and_b32 v0, 63, v0
    v_readfirstlane_b32 s3, v1
    s_lshr_b32 s28, s2, 3
    s_and_b32 s29, s2, 7
    v_lshrrev_b32 v1, 4, v0
    v_and_b32 v2, 15, v0
    v_lshlrev_b32 v3, 4, v0
    s_cmp_ge_u32 s3, 4
    s_cbranch_scc1 L_help
    v_lshlrev_b32 v24, 4, v2
    v_lshl_add_u32 v21, v1, 13, v24
    v_mul_u32_u24 v22, 7168, v1
    v_add_u32 v22, v22, v24
    v_lshlrev_b32 v25, 5, v0
    v_lshl_add_u32 v26, v2, 2, v1
    v_lshlrev_b32 v26, 1, v26
    s_lshl_b32 s67, s29, 7
    s_mul_i32 s68, s3, 32
    s_add_u32 s67, s67, s68
    s_lshl_b32 s68, s28, 8
    s_lshl_b32 s69, s28, 23
    s_waitcnt lgkmcnt(0)
    s_mov_b32 s52, s4
    s_mov_b32 s53, s5
    s_mov_b32 s54, 2048
    s_mov_b32 s55, 0x00020000
    s_mov_b32 s40, s10
    s_mov_b32 s41, s11
    s_mov_b32 s42, 8388608
    s_mov_b32 s43, 0x00020000
    s_lshl_b32 s64, s67, 1
    buffer_load_dwordx4 v[40:43], v25, s[52:55], 0 offen
    buffer_load_dwordx4 v[44:47], v25, s[52:55], 0 offen offset:16
    buffer_load_ushort v19, v26, s[52:55], s64 offen
    s_lshl_b32 s64, s67, 13
    s_add_u32 s64, s64, s68
    buffer_load_dwordx4 v[80:83], v21, s[40:43], s64 offen nt
    s_add_u32 s64, s64, 32768
    buffer_load_dwordx4 v[84:87], v21, s[40:43], s64 offen nt
    s_add_u32 s64, s64, 32768
    buffer_load_dwordx4 v[88:91], v21, s[40:43], s64 offen nt
    s_add_u32 s64, s64, 32768
    buffer_load_dwordx4 v[92:95], v21, s[40:43], s64 offen nt
    s_add_u32 s64, s64, 32768
    buffer_load_dwordx4 v[96:99], v21, s[40:43], s64 offen nt
    s_add_u32 s64, s64, 32768
    buffer_load_dwordx4 v[100:103], v21, s[40:43], s64 offen nt
    s_add_u32 s64, s64, 32768
    buffer_load_dwordx4 v[104:107], v21, s[40:43], s64 offen nt
    s_add_u32 s64, s64, 32768
    buffer_load_dwordx4 v[108:111], v21, s[40:43], s64 offen nt
L_noload:
    s_mov_b32 s44, s16
    s_mov_b32 s45, s17
    s_mov_b32 s46, 7340032
    s_mov_b32 s47, 0x00020000
    s_mov_b32 s48, s18
    s_mov_b32 s49, s19
    s_mov_b32 s50, 7340032
    s_mov_b32 s51, 0x00020000
    s_add_u32 s32, s6, s69
    s_addc_u32 s33, s7, 0
    s_add_u32 s36, s8, s69
    s_addc_u32 s37, s9, 0
    s_barrier
    s_mul_i32 s66, s67, 7168
    s_add_u32 s68, s28, 6
    s_and_b32 s68, s68, 31
    s_cmp_lt_u32 s68, 28
    s_cselect_b32 s50, s50, 0
    s_lshl_b32 s68, s68, 8
    s_add_u32 s79, s66, s68
    s_add_u32 s68, s28, 13
    s_and_b32 s68, s68, 31
    s_cmp_lt_u32 s68, 28
    s_cselect_b32 s46, s46, 0
    s_lshl_b32 s68, s68, 8
    s_add_u32 s66, s66, s68
    v_and_b32 v24, 7, v2
    v_lshrrev_b32 v24, 1, v24
    v_and_b32 v25, 1, v2
    v_lshlrev_b32 v25, 4, v25
    v_mov_b32 v26, 0xffff
    v_lshlrev_b32 v26, v25, v26
    v_cmp_eq_u32 vcc, 0, v24
    s_nop 1
    v_cndmask_b32 v4, 0, v26, vcc
    v_cmp_eq_u32 vcc, 1, v24
    s_nop 1
    v_cndmask_b32 v5, 0, v26, vcc
    v_cmp_eq_u32 vcc, 2, v24
    s_nop 1
    v_cndmask_b32 v6, 0, v26, vcc
    v_cmp_eq_u32 vcc, 3, v24
    s_nop 1
    v_cndmask_b32 v7, 0, v26, vcc
    v_and_b32 v23, 1, v1
    v_lshlrev_b32 v23, 4, v23
    v_lshl_add_u32 v23, v2, 5, v23
    s_lshl_b32 s67, s3, 9
    v_add_u32 v23, s67, v23
    v_mov_b32 v20, 1
    v_mov_b32 v17, 0
    s_mov_b32 s70, 1069066811
    s_mov_b32 s71, 1035273459
    s_mov_b32 s65, 0
    s_waitcnt vmcnt(8)
    v_lshlrev_b32 v24, 16, v40
    v_and_b32 v25, 0xffff0000, v40
    v_lshlrev_b32 v26, 16, v41
    v_and_b32 v27, 0xffff0000, v41
    v_lshlrev_b32 v28, 16, v42
    v_and_b32 v29, 0xffff0000, v42
    v_lshlrev_b32 v30, 16, v43
    v_and_b32 v31, 0xffff0000, v43
    v_lshlrev_b32 v32, 16, v44
    v_and_b32 v33, 0xffff0000, v44
    v_lshlrev_b32 v34, 16, v45
    v_and_b32 v35, 0xffff0000, v45
    v_lshlrev_b32 v36, 16, v46
    v_and_b32 v37, 0xffff0000, v46
    v_lshlrev_b32 v38, 16, v47
    v_and_b32 v39, 0xffff0000, v47
    v_add_f32 v40, v24, v25
    v_add_f32 v41, v26, v27
    v_add_f32 v42, v28, v29
    v_add_f32 v43, v30, v31
    v_add_f32 v44, v32, v33
    v_add_f32 v45, v34, v35
    v_add_f32 v46, v36, v37
    v_add_f32 v47, v38, v39
    v_add_f32 v40, v40, v44
    v_add_f32 v41, v41, v45
    v_add_f32 v42, v42, v46
    v_add_f32 v43, v43, v47
    v_add_f32 v40, v40, v42
    v_add_f32 v41, v41, v43
    v_add_f32 v40, v40, v41
    s_nop 1
    v_add_f32_dpp v40, v40, v40 quad_perm:[1,0,3,2] row_mask:0xf bank_mask:0xf
    s_nop 1
    v_add_f32_dpp v40, v40, v40 quad_perm:[2,3,0,1] row_mask:0xf bank_mask:0xf
    s_nop 1
    v_add_f32_dpp v40, v40, v40 row_half_mirror row_mask:0xf bank_mask:0xf
    s_nop 1
    v_add_f32_dpp v40, v40, v40 row_mirror row_mask:0xf bank_mask:0xf
    s_nop 1
    v_add_f32_dpp v40, v40, v40 row_bcast:15 row_mask:0xa bank_mask:0xf
    s_nop 1
    v_add_f32_dpp v40, v40, v40 row_bcast:31 row_mask:0xc bank_mask:0xf
    s_nop 0
    v_readlane_b32 s67, v40, 63
    s_nop 1
    v_mov_b32 v41, s67
    v_mul_f32 v41, 0x3a800000, v41
    v_sub_f32 v24, v24, v41
    v_sub_f32 v25, v25, v41
    v_sub_f32 v26, v26, v41
    v_sub_f32 v27, v27, v41
    v_sub_f32 v28, v28, v41
    v_sub_f32 v29, v29, v41
    v_sub_f32 v30, v30, v41
    v_sub_f32 v31, v31, v41
    v_sub_f32 v32, v32, v41
    v_sub_f32 v33, v33, v41
    v_sub_f32 v34, v34, v41
    v_sub_f32 v35, v35, v41
    v_sub_f32 v36, v36, v41
    v_sub_f32 v37, v37, v41
    v_sub_f32 v38, v38, v41
    v_sub_f32 v39, v39, v41
    v_mul_f32 v42, v24, v24
    v_mul_f32 v43, v25, v25
    v_fmac_f32 v42, v26, v26
    v_fmac_f32 v43, v27, v27
    v_fmac_f32 v42, v28, v28
    v_fmac_f32 v43, v29, v29
    v_fmac_f32 v42, v30, v30
    v_fmac_f32 v43, v31, v31
    v_fmac_f32 v42, v32, v32
    v_fmac_f32 v43, v33, v33
    v_fmac_f32 v42, v34, v34
    v_fmac_f32 v43, v35, v35
    v_fmac_f32 v42, v36, v36
    v_fmac_f32 v43, v37, v37
    v_fmac_f32 v42, v38, v38
    v_fmac_f32 v43, v39, v39
    v_add_f32 v42, v42, v43
    s_nop 1
    v_add_f32_dpp v42, v42, v42 quad_perm:[1,0,3,2] row_mask:0xf bank_mask:0xf
    s_nop 1
    v_add_f32_dpp v42, v42, v42 quad_perm:[2,3,0,1] row_mask:0xf bank_mask:0xf
    s_nop 1
    v_add_f32_dpp v42, v42, v42 row_half_mirror row_mask:0xf bank_mask:0xf
    s_nop 1
    v_add_f32_dpp v42, v42, v42 row_mirror row_mask:0xf bank_mask:0xf
    s_nop 1
    v_add_f32_dpp v42, v42, v42 row_bcast:15 row_mask:0xa bank_mask:0xf
    s_nop 1
    v_add_f32_dpp v42, v42, v42 row_bcast:31 row_mask:0xc bank_mask:0xf
    s_nop 0
    v_readlane_b32 s67, v42, 63
    s_nop 1
    v_mov_b32 v42, s67
    v_mul_f32 v42, 0x3a800000, v42
    v_cvt_pk_bf16_f32 v42, v42, v42
    v_and_b32 v42, 0xffff0000, v42
    v_add_f32 v42, 0x3727c5ac, v42
    v_cvt_pk_bf16_f32 v42, v42, v42
    v_and_b32 v42, 0xffff0000, v42
    v_sqrt_f32 v42, v42
    s_nop 0
    v_cvt_pk_bf16_f32 v42, v42, v42
    v_and_b32 v42, 0xffff0000, v42
    v_rcp_f32 v42, v42
    v_cvt_pk_bf16_f32 v41, v41, v41
    v_and_b32 v41, 0xffff0000, v41
    v_lshlrev_b32 v19, 16, v19
    v_sub_f32 v19, v19, v41
    v_cvt_pk_bf16_f32 v19, v19, v19
    v_and_b32 v19, 0xffff0000, v19
    v_mul_f32 v19, v19, v42
    v_cvt_pk_bf16_f32 v19, v19, v19
    s_lshl_b32 s73, s29, 20
    s_lshl_b32 s67, s3, 13
    s_add_u32 s73, s73, s67
    s_mov_b32 s64, s73
    s_add_u32 s72, s64, 4096
    s_mov_b64 s[40:41], s[32:33]
    s_mov_b32 s42, 8388608
    s_mov_b32 s43, 0x00020000
    s_mov_b64 s[52:53], s[32:33]
    s_mov_b32 s54, 8388608
    s_mov_b32 s55, 0x00020000
    s_cmp_ge_u32 s3, 3
    s_cselect_b32 s42, 0, s42
    s_cselect_b32 s54, 0, s54
    v_and_b32_dpp v40, v19, v4 row_newbcast:0 row_mask:0xf bank_mask:0xf
    v_and_b32_dpp v41, v19, v5 row_newbcast:0 row_mask:0xf bank_mask:0xf
    v_and_b32_dpp v42, v19, v6 row_newbcast:0 row_mask:0xf bank_mask:0xf
    v_and_b32_dpp v43, v19, v7 row_newbcast:0 row_mask:0xf bank_mask:0xf
    s_waitcnt vmcnt(7)
    s_nop 0
    v_mfma_f32_16x16x32_bf16 v[24:27], v[40:43], v[80:83], 0
    v_and_b32_dpp v44, v19, v4 row_newbcast:1 row_mask:0xf bank_mask:0xf
    v_and_b32_dpp v45, v19, v5 row_newbcast:1 row_mask:0xf bank_mask:0xf
    v_and_b32_dpp v46, v19, v6 row_newbcast:1 row_mask:0xf bank_mask:0xf
    v_and_b32_dpp v47, v19, v7 row_newbcast:1 row_mask:0xf bank_mask:0xf
    s_waitcnt vmcnt(6)
    s_nop 0
    v_mfma_f32_16x16x32_bf16 v[24:27], v[44:47], v[84:87], v[24:27]
    buffer_load_dwordx4 v[112:115], v22, s[44:47], s66 offen nt
    s_add_u32 s66, s66, 28672
    v_and_b32_dpp v40, v19, v4 row_newbcast:2 row_mask:0xf bank_mask:0xf
    v_and_b32_dpp v41, v19, v5 row_newbcast:2 row_mask:0xf bank_mask:0xf
    v_and_b32_dpp v42, v19, v6 row_newbcast:2 row_mask:0xf bank_mask:0xf
    v_and_b32_dpp v43, v19, v7 row_newbcast:2 row_mask:0xf bank_mask:0xf
    s_waitcnt vmcnt(6)
    s_nop 0
    v_mfma_f32_16x16x32_bf16 v[24:27], v[40:43], v[88:91], v[24:27]
    buffer_load_dwordx4 v[116:119], v22, s[44:47], s66 offen nt
    s_add_u32 s66, s66, 28672
    v_and_b32_dpp v44, v19, v4 row_newbcast:3 row_mask:0xf bank_mask:0xf
    v_and_b32_dpp v45, v19, v5 row_newbcast:3 row_mask:0xf bank_mask:0xf
    v_and_b32_dpp v46, v19, v6 row_newbcast:3 row_mask:0xf bank_mask:0xf
    v_and_b32_dpp v47, v19, v7 row_newbcast:3 row_mask:0xf bank_mask:0xf
    s_waitcnt vmcnt(6)
    s_nop 0
    v_mfma_f32_16x16x32_bf16 v[24:27], v[44:47], v[92:95], v[24:27]
    buffer_load_dwordx4 v[120:123], v22, s[44:47], s66 offen nt
    s_add_u32 s66, s66, 28672
    v_and_b32_dpp v40, v19, v4 row_newbcast:4 row_mask:0xf bank_mask:0xf
    v_and_b32_dpp v41, v19, v5 row_newbcast:4 row_mask:0xf bank_mask:0xf
    v_and_b32_dpp v42, v19, v6 row_newbcast:4 row_mask:0xf bank_mask:0xf
    v_and_b32_dpp v43, v19, v7 row_newbcast:4 row_mask:0xf bank_mask:0xf
    s_waitcnt vmcnt(6)
    s_nop 0
    v_mfma_f32_16x16x32_bf16 v[24:27], v[40:43], v[96:99], v[24:27]
    buffer_load_dwordx4 v[124:127], v22, s[44:47], s66 offen nt
    s_add_u32 s66, s66, 28672
    v_and_b32_dpp v44, v19, v4 row_newbcast:5 row_mask:0xf bank_mask:0xf
    v_and_b32_dpp v45, v19, v5 row_newbcast:5 row_mask:0xf bank_mask:0xf
    v_and_b32_dpp v46, v19, v6 row_newbcast:5 row_mask:0xf bank_mask:0xf
    v_and_b32_dpp v47, v19, v7 row_newbcast:5 row_mask:0xf bank_mask:0xf
    s_waitcnt vmcnt(6)
    s_nop 0
    v_mfma_f32_16x16x32_bf16 v[24:27], v[44:47], v[100:103], v[24:27]
    buffer_load_dwordx4 v[128:131], v22, s[44:47], s66 offen nt
    s_add_u32 s66, s66, 28672
    v_and_b32_dpp v40, v19, v4 row_newbcast:6 row_mask:0xf bank_mask:0xf
    v_and_b32_dpp v41, v19, v5 row_newbcast:6 row_mask:0xf bank_mask:0xf
    v_and_b32_dpp v42, v19, v6 row_newbcast:6 row_mask:0xf bank_mask:0xf
    v_and_b32_dpp v43, v19, v7 row_newbcast:6 row_mask:0xf bank_mask:0xf
    s_waitcnt vmcnt(6)
    s_nop 0
    v_mfma_f32_16x16x32_bf16 v[24:27], v[40:43], v[104:107], v[24:27]
    buffer_load_dwordx4 v[132:135], v22, s[44:47], s66 offen nt
    s_add_u32 s66, s66, 28672
    v_and_b32_dpp v44, v19, v4 row_newbcast:7 row_mask:0xf bank_mask:0xf
    v_and_b32_dpp v45, v19, v5 row_newbcast:7 row_mask:0xf bank_mask:0xf
    v_and_b32_dpp v46, v19, v6 row_newbcast:7 row_mask:0xf bank_mask:0xf
    v_and_b32_dpp v47, v19, v7 row_newbcast:7 row_mask:0xf bank_mask:0xf
    s_waitcnt vmcnt(6)
    s_nop 0
    v_mfma_f32_16x16x32_bf16 v[24:27], v[44:47], v[108:111], v[24:27]
    buffer_load_dwordx4 v[136:139], v22, s[44:47], s66 offen nt
    s_add_u32 s66, s66, 28672
    s_nop 5
    ds_write_b128 v23, v[24:27] offset:0
    s_mov_b64 exec, 1
    ds_add_u32 v17, v20 offset:21252
    s_mov_b64 exec, -1
    v_and_b32_dpp v40, v19, v4 row_newbcast:0 row_mask:0xf bank_mask:0xf
    v_and_b32_dpp v41, v19, v5 row_newbcast:0 row_mask:0xf bank_mask:0xf
    v_and_b32_dpp v42, v19, v6 row_newbcast:0 row_mask:0xf bank_mask:0xf
    v_and_b32_dpp v43, v19, v7 row_newbcast:0 row_mask:0xf bank_mask:0xf
    s_waitcnt vmcnt(6)
    s_nop 0
    v_mfma_f32_16x16x32_bf16 v[28:31], v[40:43], v[112:115], 0
    buffer_load_dwordx4 v[140:143], v22, s[44:47], s66 offen nt
    s_add_u32 s66, s66, 28672
    v_and_b32_dpp v44, v19, v4 row_newbcast:1 row_mask:0xf bank_mask:0xf
    v_and_b32_dpp v45, v19, v5 row_newbcast:1 row_mask:0xf bank_mask:0xf
    v_and_b32_dpp v46, v19, v6 row_newbcast:1 row_mask:0xf bank_mask:0xf
    v_and_b32_dpp v47, v19, v7 row_newbcast:1 row_mask:0xf bank_mask:0xf
    s_waitcnt vmcnt(6)
    s_nop 0
    v_mfma_f32_16x16x32_bf16 v[28:31], v[44:47], v[116:119], v[28:31]
    buffer_load_dwordx4 v[144:147], v22, s[48:51], s79 offen nt
    s_add_u32 s79, s79, 28672
    v_and_b32_dpp v40, v19, v4 row_newbcast:2 row_mask:0xf bank_mask:0xf
    v_and_b32_dpp v41, v19, v5 row_newbcast:2 row_mask:0xf bank_mask:0xf
    v_and_b32_dpp v42, v19, v6 row_newbcast:2 row_mask:0xf bank_mask:0xf
    v_and_b32_dpp v43, v19, v7 row_newbcast:2 row_mask:0xf bank_mask:0xf
    s_waitcnt vmcnt(6)
    s_nop 0
    v_mfma_f32_16x16x32_bf16 v[28:31], v[40:43], v[120:123], v[28:31]
    buffer_load_dwordx4 v[148:151], v22, s[48:51], s79 offen nt
    s_add_u32 s79, s79, 28672
    v_and_b32_dpp v44, v19, v4 row_newbcast:3 row_mask:0xf bank_mask:0xf
    v_and_b32_dpp v45, v19, v5 row_newbcast:3 row_mask:0xf bank_mask:0xf
    v_and_b32_dpp v46, v19, v6 row_newbcast:3 row_mask:0xf bank_mask:0xf
    v_and_b32_dpp v47, v19, v7 row_newbcast:3 row_mask:0xf bank_mask:0xf
    s_waitcnt vmcnt(6)
    s_nop 0
    v_mfma_f32_16x16x32_bf16 v[28:31], v[44:47], v[124:127], v[28:31]
    buffer_load_dwordx4 v[152:155], v22, s[48:51], s79 offen nt
    s_add_u32 s79, s79, 28672
    v_and_b32_dpp v40, v19, v4 row_newbcast:4 row_mask:0xf bank_mask:0xf
    v_and_b32_dpp v41, v19, v5 row_newbcast:4 row_mask:0xf bank_mask:0xf
    v_and_b32_dpp v42, v19, v6 row_newbcast:4 row_mask:0xf bank_mask:0xf
    v_and_b32_dpp v43, v19, v7 row_newbcast:4 row_mask:0xf bank_mask:0xf
    s_waitcnt vmcnt(6)
    s_nop 0
    v_mfma_f32_16x16x32_bf16 v[28:31], v[40:43], v[128:131], v[28:31]
    buffer_load_dwordx4 v[156:159], v22, s[48:51], s79 offen nt
    s_add_u32 s79, s79, 28672
    v_and_b32_dpp v44, v19, v4 row_newbcast:5 row_mask:0xf bank_mask:0xf
    v_and_b32_dpp v45, v19, v5 row_newbcast:5 row_mask:0xf bank_mask:0xf
    v_and_b32_dpp v46, v19, v6 row_newbcast:5 row_mask:0xf bank_mask:0xf
    v_and_b32_dpp v47, v19, v7 row_newbcast:5 row_mask:0xf bank_mask:0xf
    s_waitcnt vmcnt(6)
    s_nop 0
    v_mfma_f32_16x16x32_bf16 v[28:31], v[44:47], v[132:135], v[28:31]
    buffer_load_dwordx4 v[160:163], v22, s[48:51], s79 offen nt
    s_add_u32 s79, s79, 28672
    v_and_b32_dpp v40, v19, v4 row_newbcast:6 row_mask:0xf bank_mask:0xf
    v_and_b32_dpp v41, v19, v5 row_newbcast:6 row_mask:0xf bank_mask:0xf
    v_and_b32_dpp v42, v19, v6 row_newbcast:6 row_mask:0xf bank_mask:0xf
    v_and_b32_dpp v43, v19, v7 row_newbcast:6 row_mask:0xf bank_mask:0xf
    s_waitcnt vmcnt(6)
    s_nop 0
    v_mfma_f32_16x16x32_bf16 v[28:31], v[40:43], v[136:139], v[28:31]
    buffer_load_dwordx4 v[164:167], v22, s[48:51], s79 offen nt
    s_add_u32 s79, s79, 28672
    v_and_b32_dpp v44, v19, v4 row_newbcast:7 row_mask:0xf bank_mask:0xf
    v_and_b32_dpp v45, v19, v5 row_newbcast:7 row_mask:0xf bank_mask:0xf
    v_and_b32_dpp v46, v19, v6 row_newbcast:7 row_mask:0xf bank_mask:0xf
    v_and_b32_dpp v47, v19, v7 row_newbcast:7 row_mask:0xf bank_mask:0xf
    s_waitcnt vmcnt(6)
    s_nop 0
    v_mfma_f32_16x16x32_bf16 v[28:31], v[44:47], v[140:143], v[28:31]
    buffer_load_dwordx4 v[168:171], v22, s[48:51], s79 offen nt
    s_add_u32 s79, s79, 28672
    v_and_b32_dpp v40, v19, v4 row_newbcast:0 row_mask:0xf bank_mask:0xf
    v_and_b32_dpp v41, v19, v5 row_newbcast:0 row_mask:0xf bank_mask:0xf
    v_and_b32_dpp v42, v19, v6 row_newbcast:0 row_mask:0xf bank_mask:0xf
    v_and_b32_dpp v43, v19, v7 row_newbcast:0 row_mask:0xf bank_mask:0xf
    s_waitcnt vmcnt(6)
    s_nop 0
    v_mfma_f32_16x16x32_bf16 v[32:35], v[40:43], v[144:147], 0
    buffer_load_dwordx4 v[172:175], v22, s[48:51], s79 offen nt
    s_add_u32 s79, s79, 28672
    v_and_b32_dpp v44, v19, v4 row_newbcast:1 row_mask:0xf bank_mask:0xf
    v_and_b32_dpp v45, v19, v5 row_newbcast:1 row_mask:0xf bank_mask:0xf
    v_and_b32_dpp v46, v19, v6 row_newbcast:1 row_mask:0xf bank_mask:0xf
    v_and_b32_dpp v47, v19, v7 row_newbcast:1 row_mask:0xf bank_mask:0xf
    s_waitcnt vmcnt(6)
    s_nop 0
    v_mfma_f32_16x16x32_bf16 v[32:35], v[44:47], v[148:151], v[32:35]
    buffer_load_dwordx4 v[48:51], v3, s[40:43], s64 offen offset:0 nt
    v_and_b32_dpp v40, v19, v4 row_newbcast:2 row_mask:0xf bank_mask:0xf
    v_and_b32_dpp v41, v19, v5 row_newbcast:2 row_mask:0xf bank_mask:0xf
    v_and_b32_dpp v42, v19, v6 row_newbcast:2 row_mask:0xf bank_mask:0xf
    v_and_b32_dpp v43, v19, v7 row_newbcast:2 row_mask:0xf bank_mask:0xf
    s_waitcnt vmcnt(6)
    s_nop 0
    v_mfma_f32_16x16x32_bf16 v[32:35], v[40:43], v[152:155], v[32:35]
    buffer_load_dwordx4 v[52:55], v3, s[40:43], s64 offen offset:1024 nt
    v_and_b32_dpp v44, v19, v4 row_newbcast:3 row_mask:0xf bank_mask:0xf
    v_and_b32_dpp v45, v19, v5 row_newbcast:3 row_mask:0xf bank_mask:0xf
    v_and_b32_dpp v46, v19, v6 row_newbcast:3 row_mask:0xf bank_mask:0xf
    v_and_b32_dpp v47, v19, v7 row_newbcast:3 row_mask:0xf bank_mask:0xf
    s_waitcnt vmcnt(6)
    s_nop 0
    v_mfma_f32_16x16x32_bf16 v[32:35], v[44:47], v[156:159], v[32:35]
    buffer_load_dwordx4 v[56:59], v3, s[40:43], s64 offen offset:2048 nt
    v_and_b32_dpp v40, v19, v4 row_newbcast:4 row_mask:0xf bank_mask:0xf
    v_and_b32_dpp v41, v19, v5 row_newbcast:4 row_mask:0xf bank_mask:0xf
    v_and_b32_dpp v42, v19, v6 row_newbcast:4 row_mask:0xf bank_mask:0xf
    v_and_b32_dpp v43, v19, v7 row_newbcast:4 row_mask:0xf bank_mask:0xf
    s_waitcnt vmcnt(6)
    s_nop 0
    v_mfma_f32_16x16x32_bf16 v[32:35], v[40:43], v[160:163], v[32:35]
    buffer_load_dwordx4 v[60:63], v3, s[40:43], s64 offen offset:3072 nt
    v_and_b32_dpp v44, v19, v4 row_newbcast:5 row_mask:0xf bank_mask:0xf
    v_and_b32_dpp v45, v19, v5 row_newbcast:5 row_mask:0xf bank_mask:0xf
    v_and_b32_dpp v46, v19, v6 row_newbcast:5 row_mask:0xf bank_mask:0xf
    v_and_b32_dpp v47, v19, v7 row_newbcast:5 row_mask:0xf bank_mask:0xf
    s_waitcnt vmcnt(6)
    s_nop 0
    v_mfma_f32_16x16x32_bf16 v[32:35], v[44:47], v[164:167], v[32:35]
    buffer_load_dwordx4 v[64:67], v3, s[52:55], s72 offen offset:0 nt
    v_and_b32_dpp v40, v19, v4 row_newbcast:6 row_mask:0xf bank_mask:0xf
    v_and_b32_dpp v41, v19, v5 row_newbcast:6 row_mask:0xf bank_mask:0xf
    v_and_b32_dpp v42, v19, v6 row_newbcast:6 row_mask:0xf bank_mask:0xf
    v_and_b32_dpp v43, v19, v7 row_newbcast:6 row_mask:0xf bank_mask:0xf
    s_waitcnt vmcnt(6)
    s_nop 0
    v_mfma_f32_16x16x32_bf16 v[32:35], v[40:43], v[168:171], v[32:35]
    buffer_load_dwordx4 v[68:71], v3, s[52:55], s72 offen offset:1024 nt
    v_and_b32_dpp v44, v19, v4 row_newbcast:7 row_mask:0xf bank_mask:0xf
    v_and_b32_dpp v45, v19, v5 row_newbcast:7 row_mask:0xf bank_mask:0xf
    v_and_b32_dpp v46, v19, v6 row_newbcast:7 row_mask:0xf bank_mask:0xf
    v_and_b32_dpp v47, v19, v7 row_newbcast:7 row_mask:0xf bank_mask:0xf
    s_waitcnt vmcnt(6)
    s_nop 0
    v_mfma_f32_16x16x32_bf16 v[32:35], v[44:47], v[172:175], v[32:35]
    buffer_load_dwordx4 v[72:75], v3, s[52:55], s72 offen offset:2048 nt
    s_waitcnt vmcnt(6)
    buffer_load_dwordx4 v[76:79], v3, s[52:55], s72 offen offset:3072 nt
    ds_write_b128 v23, v[28:31] offset:4096
    s_nop 3
    ds_write_b128 v23, v[32:35] offset:8192
    s_mov_b64 exec, 1
    ds_add_u32 v17, v20 offset:21256
    s_mov_b64 exec, -1
L_nogu:
    s_waitcnt lgkmcnt(0)
    s_cmp_ge_u32 s3, 3
    s_cbranch_scc1 L_end
    v_mov_b32 v12, 0
    v_mov_b32 v13, 0
    v_mov_b32 v14, 0
    v_mov_b32 v15, 0
    v_mov_b32 v18, 0xff800000
    v_mov_b32 v21, 21248
    v_lshlrev_b32 v22, 4, v2
    v_lshrrev_b32 v39, 2, v2
    v_lshl_add_u32 v39, v1, 2, v39
    v_lshlrev_b32 v39, 2, v39
    s_mul_i32 s67, s3, 5248
    v_add_u32 v39, s67, v39
    s_mov_b32 s76, 41
    s_mov_b32 s30, 2097152
L_lw_q:
    ds_read_b32 v36, v17 offset:21260
    s_waitcnt lgkmcnt(0)
    v_readfirstlane_b32 s68, v36
    s_cmp_ge_u32 s68, 1
    s_cbranch_scc1 L_lwd_q
    s_sleep 1
    s_sub_u32 s30, s30, 1
    s_cmp_lg_u32 s30, 0
    s_cbranch_scc1 L_lw_q
L_lwd_q:
    ds_read_b128 v[8:11], v22 offset:20480
    s_waitcnt lgkmcnt(0)
.p2align 6
L_kloop:
    s_add_u32 s64, s64, 24576
    s_sub_u32 s76, s76, 1
    s_cmp_lg_u32 s76, 0
    s_cbranch_scc1 L_kgo
    s_mov_b32 s64, s73
    s_mov_b64 s[40:41], s[36:37]
    s_mov_b64 s[52:53], s[36:37]
L_kgo:
    s_add_u32 s72, s64, 4096
    s_waitcnt vmcnt(0)
    v_dot2_f32_bf16 v24, v48, v8, 0
    v_dot2_f32_bf16 v25, v52, v8, 0
    v_dot2_f32_bf16 v26, v56, v8, 0
    v_dot2_f32_bf16 v27, v60, v8, 0
    v_dot2_f32_bf16 v24, v49, v9, v24
    v_dot2_f32_bf16 v25, v53, v9, v25
    v_dot2_f32_bf16 v26, v57, v9, v26
    v_dot2_f32_bf16 v27, v61, v9, v27
    v_dot2_f32_bf16 v24, v50, v10, v24
    v_dot2_f32_bf16 v25, v54, v10, v25
    v_dot2_f32_bf16 v26, v58, v10, v26
    v_dot2_f32_bf16 v27, v62, v10, v27
    v_dot2_f32_bf16 v24, v51, v11, v24
    v_dot2_f32_bf16 v25, v55, v11, v25
    v_dot2_f32_bf16 v26, v59, v11, v26
    v_dot2_f32_bf16 v27, v63, v11, v27
    v_add_f32_dpp v28, v24, v24 row_ror:8 row_mask:0xf bank_mask:0x3
    v_add_f32_dpp v29, v25, v25 row_ror:8 row_mask:0xf bank_mask:0x3
    v_add_f32_dpp v28, v26, v26 row_ror:8 row_mask:0xf bank_mask:0xc
    v_add_f32_dpp v29, v27, v27 row_ror:8 row_mask:0xf bank_mask:0xc
    s_nop 0
    v_add_f32_dpp v30, v28, v28 row_half_mirror row_mask:0xf bank_mask:0x5
    v_add_f32_dpp v30, v29, v29 row_half_mirror row_mask:0xf bank_mask:0xa
    s_nop 1
    v_add_f32_dpp v30, v30, v30 quad_perm:[1,0,3,2] row_mask:0xf bank_mask:0xf
    s_nop 1
    v_add_f32_dpp v30, v30, v30 quad_perm:[2,3,0,1] row_mask:0xf bank_mask:0xf
    v_cvt_pk_bf16_f32 v30, v30, v30
    v_and_b32 v30, 0xffff0000, v30
    v_mul_f32 v30, s71, v30
    v_cvt_pk_bf16_f32 v30, v30, v30
    v_and_b32 v30, 0xffff0000, v30
    ds_write_b32 v39, v30 offset:31744
    v_max_f32 v18, v18, v30
    v_dot2_f32_bf16 v24, v64, v8, 0
    v_dot2_f32_bf16 v25, v68, v8, 0
    v_dot2_f32_bf16 v26, v72, v8, 0
    v_dot2_f32_bf16 v27, v76, v8, 0
    v_dot2_f32_bf16 v24, v65, v9, v24
    v_dot2_f32_bf16 v25, v69, v9, v25
    v_dot2_f32_bf16 v26, v73, v9, v26
    v_dot2_f32_bf16 v27, v77, v9, v27
    v_dot2_f32_bf16 v24, v66, v10, v24
    v_dot2_f32_bf16 v25, v70, v10, v25
    v_dot2_f32_bf16 v26, v74, v10, v26
    v_dot2_f32_bf16 v27, v78, v10, v27
    v_dot2_f32_bf16 v24, v67, v11, v24
    v_dot2_f32_bf16 v25, v71, v11, v25
    v_dot2_f32_bf16 v26, v75, v11, v26
    v_dot2_f32_bf16 v27, v79, v11, v27
    buffer_load_dwordx4 v[48:51], v3, s[40:43], s64 offen offset:0 nt
    buffer_load_dwordx4 v[52:55], v3, s[40:43], s64 offen offset:1024 nt
    buffer_load_dwordx4 v[56:59], v3, s[40:43], s64 offen offset:2048 nt
    buffer_load_dwordx4 v[60:63], v3, s[40:43], s64 offen offset:3072 nt
    buffer_load_dwordx4 v[64:67], v3, s[52:55], s72 offen offset:0 nt
    buffer_load_dwordx4 v[68:71], v3, s[52:55], s72 offen offset:1024 nt
    buffer_load_dwordx4 v[72:75], v3, s[52:55], s72 offen offset:2048 nt
    buffer_load_dwordx4 v[76:79], v3, s[52:55], s72 offen offset:3072 nt
    v_add_f32_dpp v28, v24, v24 row_ror:8 row_mask:0xf bank_mask:0x3
    v_add_f32_dpp v29, v25, v25 row_ror:8 row_mask:0xf bank_mask:0x3
    v_add_f32_dpp v28, v26, v26 row_ror:8 row_mask:0xf bank_mask:0xc
    v_add_f32_dpp v29, v27, v27 row_ror:8 row_mask:0xf bank_mask:0xc
    s_nop 0
    v_add_f32_dpp v30, v28, v28 row_half_mirror row_mask:0xf bank_mask:0x5
    v_add_f32_dpp v30, v29, v29 row_half_mirror row_mask:0xf bank_mask:0xa
    s_nop 1
    v_add_f32_dpp v30, v30, v30 quad_perm:[1,0,3,2] row_mask:0xf bank_mask:0xf
    s_nop 1
    v_add_f32_dpp v30, v30, v30 quad_perm:[2,3,0,1] row_mask:0xf bank_mask:0xf
    v_cvt_pk_bf16_f32 v30, v30, v30
    v_and_b32 v30, 0xffff0000, v30
    v_mul_f32 v30, s71, v30
    v_cvt_pk_bf16_f32 v30, v30, v30
    v_and_b32 v30, 0xffff0000, v30
    ds_write_b32 v39, v30 offset:31808
    v_max_f32 v18, v18, v30
    v_add_u32 v39, 128, v39
    s_cmp_lg_u32 s76, 0
    s_cbranch_scc1 L_kloop
    v_subrev_u32 v39, 5248, v39
    v_max_f32_dpp v31, v18, v18 row_ror:4 row_mask:0xf bank_mask:0xf
    s_nop 1
    v_max_f32_dpp v31, v31, v31 row_ror:8 row_mask:0xf bank_mask:0xf
    s_nop 1
    v_max_f32_dpp v31, v31, v31 row_bcast:15 row_mask:0xa bank_mask:0xf
    s_nop 1
    v_max_f32_dpp v31, v31, v31 row_bcast:31 row_mask:0xc bank_mask:0xf
    s_nop 0
    v_readlane_b32 s67, v31, 63
    s_nop 1
    v_mov_b32 v18, s67
    v_mul_f32 v16, 0xbfb8aa3b, v18
    s_mov_b32 s76, 41
.p2align 6
L_vloop:
    ds_read_b32 v37, v39 offset:31744
    ds_read_b32 v38, v39 offset:31808
    v_add_u32 v39, 128, v39
    s_add_u32 s64, s64, 24576
    s_add_u32 s72, s64, 4096
    s_sub_u32 s76, s76, 1
    s_cmp_lg_u32 s76, 0
    s_cbranch_scc1 L_vgo
    s_mov_b64 s[40:41], s[32:33]
    s_mov_b64 exec, 1
    ds_add_rtn_u32 v19, v21, v20
    s_mov_b32 s68, 1048576
    s_waitcnt lgkmcnt(0)
    v_lshlrev_b32 v24, 2, v19
L_tq_retryv:
    ds_read_b32 v19, v24 offset:21504
    s_waitcnt lgkmcnt(0)
    v_readfirstlane_b32 s64, v19
    s_cmp_lg_u32 s64, -1
    s_cbranch_scc1 L_gov
    s_sleep 1
    s_sub_u32 s68, s68, 1
    s_cmp_lg_u32 s68, 0
    s_cbranch_scc1 L_tq_retryv
    s_mov_b32 s64, 0x80000000
L_gov:
    s_mov_b64 exec, -1
    s_mov_b32 s72, s64
L_vgo:
    s_waitcnt lgkmcnt(0)
    v_fma_f32 v37, v37, s70, v16
    v_exp_f32 v37, v37
    v_fma_f32 v38, v38, s70, v16
    v_exp_f32 v38, v38
    v_add_f32 v17, v17, v37
    v_cvt_pk_bf16_f32 v37, v37, v37
    v_add_f32 v17, v17, v38
    v_cvt_pk_bf16_f32 v38, v38, v38
    s_waitcnt vmcnt(0)
    v_and_b32_dpp v40, v37, v4 row_newbcast:0 row_mask:0xf bank_mask:0xf
    v_and_b32_dpp v41, v37, v5 row_newbcast:0 row_mask:0xf bank_mask:0xf
    v_and_b32_dpp v42, v37, v6 row_newbcast:0 row_mask:0xf bank_mask:0xf
    v_and_b32_dpp v43, v37, v7 row_newbcast:0 row_mask:0xf bank_mask:0xf
    s_nop 1
    v_mfma_f32_16x16x32_bf16 v[12:15], v[40:43], v[48:51], v[12:15]
    v_and_b32_dpp v44, v37, v4 row_newbcast:4 row_mask:0xf bank_mask:0xf
    v_and_b32_dpp v45, v37, v5 row_newbcast:4 row_mask:0xf bank_mask:0xf
    v_and_b32_dpp v46, v37, v6 row_newbcast:4 row_mask:0xf bank_mask:0xf
    v_and_b32_dpp v47, v37, v7 row_newbcast:4 row_mask:0xf bank_mask:0xf
    s_nop 1
    v_mfma_f32_16x16x32_bf16 v[12:15], v[44:47], v[52:55], v[12:15]
    v_and_b32_dpp v40, v37, v4 row_newbcast:8 row_mask:0xf bank_mask:0xf
    v_and_b32_dpp v41, v37, v5 row_newbcast:8 row_mask:0xf bank_mask:0xf
    v_and_b32_dpp v42, v37, v6 row_newbcast:8 row_mask:0xf bank_mask:0xf
    v_and_b32_dpp v43, v37, v7 row_newbcast:8 row_mask:0xf bank_mask:0xf
    s_nop 1
    v_mfma_f32_16x16x32_bf16 v[12:15], v[40:43], v[56:59], v[12:15]
    v_and_b32_dpp v44, v37, v4 row_newbcast:12 row_mask:0xf bank_mask:0xf
    v_and_b32_dpp v45, v37, v5 row_newbcast:12 row_mask:0xf bank_mask:0xf
    v_and_b32_dpp v46, v37, v6 row_newbcast:12 row_mask:0xf bank_mask:0xf
    v_and_b32_dpp v47, v37, v7 row_newbcast:12 row_mask:0xf bank_mask:0xf
    s_nop 1
    v_mfma_f32_16x16x32_bf16 v[12:15], v[44:47], v[60:63], v[12:15]
    v_and_b32_dpp v40, v38, v4 row_newbcast:0 row_mask:0xf bank_mask:0xf
    v_and_b32_dpp v41, v38, v5 row_newbcast:0 row_mask:0xf bank_mask:0xf
    v_and_b32_dpp v42, v38, v6 row_newbcast:0 row_mask:0xf bank_mask:0xf
    v_and_b32_dpp v43, v38, v7 row_newbcast:0 row_mask:0xf bank_mask:0xf
    s_nop 1
    v_mfma_f32_16x16x32_bf16 v[12:15], v[40:43], v[64:67], v[12:15]
    v_and_b32_dpp v44, v38, v4 row_newbcast:4 row_mask:0xf bank_mask:0xf
    v_and_b32_dpp v45, v38, v5 row_newbcast:4 row_mask:0xf bank_mask:0xf
    v_and_b32_dpp v46, v38, v6 row_newbcast:4 row_mask:0xf bank_mask:0xf
    v_and_b32_dpp v47, v38, v7 row_newbcast:4 row_mask:0xf bank_mask:0xf
    s_nop 1
    v_mfma_f32_16x16x32_bf16 v[12:15], v[44:47], v[68:71], v[12:15]
    v_and_b32_dpp v40, v38, v4 row_newbcast:8 row_mask:0xf bank_mask:0xf
    v_and_b32_dpp v41, v38, v5 row_newbcast:8 row_mask:0xf bank_mask:0xf
    v_and_b32_dpp v42, v38, v6 row_newbcast:8 row_mask:0xf bank_mask:0xf
    v_and_b32_dpp v43, v38, v7 row_newbcast:8 row_mask:0xf bank_mask:0xf
    s_nop 1
    v_mfma_f32_16x16x32_bf16 v[12:15], v[40:43], v[72:75], v[12:15]
    v_and_b32_dpp v44, v38, v4 row_newbcast:12 row_mask:0xf bank_mask:0xf
    v_and_b32_dpp v45, v38, v5 row_newbcast:12 row_mask:0xf bank_mask:0xf
    v_and_b32_dpp v46, v38, v6 row_newbcast:12 row_mask:0xf bank_mask:0xf
    v_and_b32_dpp v47, v38, v7 row_newbcast:12 row_mask:0xf bank_mask:0xf
    s_nop 1
    v_mfma_f32_16x16x32_bf16 v[12:15], v[44:47], v[76:79], v[12:15]
    buffer_load_dwordx4 v[48:51], v3, s[40:43], s64 offen offset:0 nt
    buffer_load_dwordx4 v[52:55], v3, s[40:43], s64 offen offset:1024 nt
    buffer_load_dwordx4 v[56:59], v3, s[40:43], s64 offen offset:2048 nt
    buffer_load_dwordx4 v[60:63], v3, s[40:43], s64 offen offset:3072 nt
    buffer_load_dwordx4 v[64:67], v3, s[52:55], s72 offen offset:0 nt
    buffer_load_dwordx4 v[68:71], v3, s[52:55], s72 offen offset:1024 nt
    buffer_load_dwordx4 v[72:75], v3, s[52:55], s72 offen offset:2048 nt
    buffer_load_dwordx4 v[76:79], v3, s[52:55], s72 offen offset:3072 nt
    s_cmp_lg_u32 s76, 0
    s_cbranch_scc1 L_vloop
    s_cmp_ge_u32 s64, 0x80000000
    s_cbranch_scc1 L_done
.p2align 6
L_loop:
    s_mov_b64 exec, 1
    ds_add_rtn_u32 v19, v21, v20
    s_mov_b32 s68, 1048576
    s_waitcnt lgkmcnt(0)
    v_lshlrev_b32 v24, 2, v19
L_tq_retryf:
    ds_read_b32 v19, v24 offset:21504
    s_waitcnt lgkmcnt(0)
    v_readfirstlane_b32 s64, v19
    s_cmp_lg_u32 s64, -1
    s_cbranch_scc1 L_gof
    s_sleep 1
    s_sub_u32 s68, s68, 1
    s_cmp_lg_u32 s68, 0
    s_cbranch_scc1 L_tq_retryf
    s_mov_b32 s64, 0x80000000
L_gof:
    s_mov_b64 exec, -1
    s_mov_b32 s72, s64
    s_waitcnt vmcnt(4)
    v_dot2_f32_bf16 v24, v48, v8, 0
    v_dot2_f32_bf16 v25, v52, v8, 0
    v_dot2_f32_bf16 v26, v56, v8, 0
    v_dot2_f32_bf16 v27, v60, v8, 0
    v_dot2_f32_bf16 v24, v49, v9, v24
    v_dot2_f32_bf16 v25, v53, v9, v25
    v_dot2_f32_bf16 v26, v57, v9, v26
    v_dot2_f32_bf16 v27, v61, v9, v27
    v_dot2_f32_bf16 v24, v50, v10, v24
    v_dot2_f32_bf16 v25, v54, v10, v25
    v_dot2_f32_bf16 v26, v58, v10, v26
    v_dot2_f32_bf16 v27, v62, v10, v27
    v_dot2_f32_bf16 v24, v51, v11, v24
    v_dot2_f32_bf16 v25, v55, v11, v25
    v_dot2_f32_bf16 v26, v59, v11, v26
    v_dot2_f32_bf16 v27, v63, v11, v27
    buffer_load_dwordx4 v[48:51], v3, s[40:43], s64 offen offset:0 nt
    buffer_load_dwordx4 v[52:55], v3, s[40:43], s64 offen offset:1024 nt
    buffer_load_dwordx4 v[56:59], v3, s[40:43], s64 offen offset:2048 nt
    buffer_load_dwordx4 v[60:63], v3, s[40:43], s64 offen offset:3072 nt
    v_add_f32_dpp v28, v24, v24 row_ror:8 row_mask:0xf bank_mask:0x3
    v_add_f32_dpp v29, v25, v25 row_ror:8 row_mask:0xf bank_mask:0x3
    v_add_f32_dpp v28, v26, v26 row_ror:8 row_mask:0xf bank_mask:0xc
    v_add_f32_dpp v29, v27, v27 row_ror:8 row_mask:0xf bank_mask:0xc
    s_nop 0
    v_add_f32_dpp v30, v28, v28 row_half_mirror row_mask:0xf bank_mask:0x5
    v_add_f32_dpp v30, v29, v29 row_half_mirror row_mask:0xf bank_mask:0xa
    s_nop 1
    v_add_f32_dpp v30, v30, v30 quad_perm:[1,0,3,2] row_mask:0xf bank_mask:0xf
    s_nop 1
    v_add_f32_dpp v30, v30, v30 quad_perm:[2,3,0,1] row_mask:0xf bank_mask:0xf
    v_cvt_pk_bf16_f32 v30, v30, v30
    v_and_b32 v30, 0xffff0000, v30
    v_mul_f32 v30, s71, v30
    v_cvt_pk_bf16_f32 v30, v30, v30
    v_and_b32 v30, 0xffff0000, v30
    v_cmp_lt_f32 vcc, v18, v30
    s_cbranch_vccnz L_rare0
L_back0:
    v_fma_f32 v32, v30, s70, v16
    v_exp_f32 v32, v32
    s_nop 0
    v_add_f32 v17, v17, v32
    v_cvt_pk_bf16_f32 v32, v32, v32
    s_nop 1
    v_and_b32_dpp v40, v32, v4 row_newbcast:0 row_mask:0xf bank_mask:0xf
    v_and_b32_dpp v41, v32, v5 row_newbcast:0 row_mask:0xf bank_mask:0xf
    v_and_b32_dpp v42, v32, v6 row_newbcast:0 row_mask:0xf bank_mask:0xf
    v_and_b32_dpp v43, v32, v7 row_newbcast:0 row_mask:0xf bank_mask:0xf
    s_waitcnt vmcnt(4)
    s_nop 0
    v_mfma_f32_16x16x32_bf16 v[12:15], v[40:43], v[64:67], v[12:15]
    v_and_b32_dpp v44, v32, v4 row_newbcast:4 row_mask:0xf bank_mask:0xf
    v_and_b32_dpp v45, v32, v5 row_newbcast:4 row_mask:0xf bank_mask:0xf
    v_and_b32_dpp v46, v32, v6 row_newbcast:4 row_mask:0xf bank_mask:0xf
    v_and_b32_dpp v47, v32, v7 row_newbcast:4 row_mask:0xf bank_mask:0xf
    s_nop 1
    v_mfma_f32_16x16x32_bf16 v[12:15], v[44:47], v[68:71], v[12:15]
    v_and_b32_dpp v40, v32, v4 row_newbcast:8 row_mask:0xf bank_mask:0xf
    v_and_b32_dpp v41, v32, v5 row_newbcast:8 row_mask:0xf bank_mask:0xf
    v_and_b32_dpp v42, v32, v6 row_newbcast:8 row_mask:0xf bank_mask:0xf
    v_and_b32_dpp v43, v32, v7 row_newbcast:8 row_mask:0xf bank_mask:0xf
    s_nop 1
    v_mfma_f32_16x16x32_bf16 v[12:15], v[40:43], v[72:75], v[12:15]
    v_and_b32_dpp v44, v32, v4 row_newbcast:12 row_mask:0xf bank_mask:0xf
    v_and_b32_dpp v45, v32, v5 row_newbcast:12 row_mask:0xf bank_mask:0xf
    v_and_b32_dpp v46, v32, v6 row_newbcast:12 row_mask:0xf bank_mask:0xf
    v_and_b32_dpp v47, v32, v7 row_newbcast:12 row_mask:0xf bank_mask:0xf
    s_nop 1
    v_mfma_f32_16x16x32_bf16 v[12:15], v[44:47], v[76:79], v[12:15]
    buffer_load_dwordx4 v[64:67], v3, s[52:55], s72 offen offset:0 nt
    buffer_load_dwordx4 v[68:71], v3, s[52:55], s72 offen offset:1024 nt
    buffer_load_dwordx4 v[72:75], v3, s[52:55], s72 offen offset:2048 nt
    buffer_load_dwordx4 v[76:79], v3, s[52:55], s72 offen offset:3072 nt
    s_cmp_lt_u32 s64, 0x80000000
    s_cbranch_scc1 L_loop
L_done:
    v_add_f32_dpp v17, v17, v17 row_ror:4 row_mask:0xf bank_mask:0xf
    s_nop 1
    v_add_f32_dpp v17, v17, v17 row_ror:8 row_mask:0xf bank_mask:0xf
    s_nop 1
    v_add_f32_dpp v17, v17, v17 row_bcast:15 row_mask:0xa bank_mask:0xf
    s_nop 1
    v_add_f32_dpp v17, v17, v17 row_bcast:31 row_mask:0xc bank_mask:0xf
    ds_write_b128 v23, v[12:15] offset:12288
    v_readlane_b32 s67, v17, 63
    s_lshl_b32 s68, s3, 3
    v_mov_b32 v24, s68
    v_mov_b32 v17, s67
    ds_write_b64 v24, v[16:17] offset:20992
    s_waitcnt lgkmcnt(0)
    s_barrier
    s_endpgm
L_rare0:
    s_nop 1
    v_max_f32_dpp v31, v30, v30 row_ror:4 row_mask:0xf bank_mask:0xf
    s_nop 1
    v_max_f32_dpp v31, v31, v31 row_ror:8 row_mask:0xf bank_mask:0xf
    s_nop 1
    v_max_f32_dpp v31, v31, v31 row_bcast:15 row_mask:0xa bank_mask:0xf
    s_nop 1
    v_max_f32_dpp v31, v31, v31 row_bcast:31 row_mask:0xc bank_mask:0xf
    s_nop 0
    v_readlane_b32 s67, v31, 63
    s_nop 1
    v_mov_b32 v18, s67
    v_mul_f32 v31, 0xbfb8aa3b, v18
    v_sub_f32 v28, v31, v16
    v_exp_f32 v28, v28
    v_mov_b32 v16, v31
    v_mul_f32 v17, v17, v28
    v_mul_f32 v12, v12, v28
    v_mul_f32 v13, v13, v28
    v_mul_f32 v14, v14, v28
    v_mul_f32 v15, v15, v28
    s_branch L_back0
.p2align 6
L_help:
    v_mov_b32 v28, 0
    v_lshlrev_b32 v29, 22, v0
    v_lshlrev_b32 v26, 3, v0
    v_lshlrev_b32 v30, 2, v0
    v_and_b32 v33, 7, v0
    v_lshlrev_b32 v34, 11, v33
    v_lshlrev_b32 v38, 2, v33
    v_lshlrev_b32 v33, 3, v33
    v_mov_b32 v12, 0
    v_mov_b32 v13, 0
    v_mov_b32 v14, 0
    v_mov_b32 v15, 0
    ds_write_b128 v28, v[12:15] offset:21248
    ds_write_b32 v28, v28 offset:21264
    s_lshl_b32 s67, s29, 8
    s_lshr_b32 s68, s28, 2
    s_lshl_b32 s68, s68, 5
    s_add_u32 s64, s67, s68
    s_waitcnt lgkmcnt(0)
    s_mov_b32 s56, s26
    s_mov_b32 s57, s27
    s_mov_b32 s58, 4194304
    s_mov_b32 s59, 0x00020000
    s_mov_b32 s52, s4
    s_mov_b32 s53, s5
    s_mov_b32 s54, 2048
    s_mov_b32 s55, 0x00020000
    buffer_load_dword v24, v28, s[56:59], 0 offen sc1
    buffer_load_dword v25, v38, s[52:55], s64 offen
    s_cmp_lg_u32 s3, 4
    s_cbranch_scc1 L_ft
    s_mul_i32 s69, s28, 4352
    s_add_u32 s69, s69, 0x300000
    s_cmp_lg_u32 s29, 0
    s_cbranch_scc1 L_c_noinit
    buffer_store_dword v28, v29, s[56:59], s69 offen sc1
L_c_noinit:
    s_barrier
    v_mov_b32 v48, -1
    v_mov_b32 v49, -1
    v_mov_b32 v50, -1
    v_mov_b32 v51, -1
    ds_write_b128 v3, v[48:51] offset:21504
    v_mov_b32 v12, 0x7f800000
    ds_write_b64 v33, v[12:13] offset:20992
    s_lshl_b32 s67, s2, 10
    s_add_u32 s67, s67, 65536
    s_lshl_b32 s32, s28, 13
    s_add_u32 s32, s32, 65536
    s_add_u32 s33, s32, 4096
    s_waitcnt vmcnt(0)
    v_add_u32 v24, 1, v24
    v_mov_b32 v9, v24
    v_mov_b32 v11, v24
    v_mov_b32 v17, v24
    v_mov_b32 v19, v24
    s_mov_b32 s30, 2097152
L_lw_qc:
    ds_read_b32 v12, v28 offset:21252
    s_waitcnt lgkmcnt(0)
    v_readfirstlane_b32 s68, v12
    s_cmp_ge_u32 s68, 4
    s_cbranch_scc1 L_lwd_qc
    s_sleep 1
    s_sub_u32 s30, s30, 1
    s_cmp_lg_u32 s30, 0
    s_cbranch_scc1 L_lw_qc
L_lwd_qc:
    ds_read_b64 v[48:49], v26 offset:0
    ds_read_b64 v[50:51], v26 offset:512
    ds_read_b64 v[52:53], v26 offset:1024
    ds_read_b64 v[54:55], v26 offset:1536
    s_waitcnt lgkmcnt(0)
    v_add_f32 v8, v48, v50
    v_add_f32 v10, v49, v51
    v_add_f32 v8, v8, v52
    v_add_f32 v10, v10, v53
    v_add_f32 v8, v8, v54
    v_add_f32 v10, v10, v55
    buffer_store_dwordx4 v[8:11], v3, s[56:59], s67 offen sc1
    s_waitcnt vmcnt(0)
    s_mov_b32 s30, 131072
L_poll_q:
    buffer_load_dwordx4 v[48:51], v3, s[56:59], s32 offen offset:0 sc1
    buffer_load_dwordx4 v[52:55], v3, s[56:59], s32 offen offset:1024 sc1
    buffer_load_dwordx4 v[56:59], v3, s[56:59], s32 offen offset:2048 sc1
    buffer_load_dwordx4 v[60:63], v3, s[56:59], s32 offen offset:3072 sc1
    buffer_load_dwordx4 v[64:67], v3, s[56:59], s33 offen offset:0 sc1
    buffer_load_dwordx4 v[68:71], v3, s[56:59], s33 offen offset:1024 sc1
    buffer_load_dwordx4 v[72:75], v3, s[56:59], s33 offen offset:2048 sc1
    buffer_load_dwordx4 v[76:79], v3, s[56:59], s33 offen offset:3072 sc1
    s_waitcnt vmcnt(0)
    v_xor_b32 v38, v49, v24
    v_xor_b32 v39, v51, v24
    v_or_b32 v27, v38, v39
    v_xor_b32 v38, v53, v24
    v_xor_b32 v39, v55, v24
    v_or3_b32 v27, v38, v39, v27
    v_xor_b32 v38, v57, v24
    v_xor_b32 v39, v59, v24
    v_or3_b32 v27, v38, v39, v27
    v_xor_b32 v38, v61, v24
    v_xor_b32 v39, v63, v24
    v_or3_b32 v27, v38, v39, v27
    v_xor_b32 v38, v65, v24
    v_xor_b32 v39, v67, v24
    v_or3_b32 v27, v38, v39, v27
    v_xor_b32 v38, v69, v24
    v_xor_b32 v39, v71, v24
    v_or3_b32 v27, v38, v39, v27
    v_xor_b32 v38, v73, v24
    v_xor_b32 v39, v75, v24
    v_or3_b32 v27, v38, v39, v27
    v_xor_b32 v38, v77, v24
    v_xor_b32 v39, v79, v24
    v_or3_b32 v27, v38, v39, v27
    v_cmp_ne_u32 vcc, 0, v27
    s_cbranch_vccz L_polled_q
    s_sleep 1
    s_sub_u32 s30, s30, 1
    s_cmp_lg_u32 s30, 0
    s_cbranch_scc1 L_poll_q
L_polled_q:
    v_add_f32 v12, v48, v52
    v_add_f32 v13, v50, v54
    v_add_f32 v12, v12, v56
    v_add_f32 v13, v13, v58
    v_add_f32 v12, v12, v60
    v_add_f32 v13, v13, v62
    v_add_f32 v12, v12, v64
    v_add_f32 v13, v13, v66
    v_add_f32 v12, v12, v68
    v_add_f32 v13, v13, v70
    v_add_f32 v12, v12, v72
    v_add_f32 v13, v13, v74
    v_add_f32 v12, v12, v76
    v_add_f32 v13, v13, v78
    v_cvt_pk_bf16_f32 v12, v12, v13
    v_mov_b32 v13, 1
    ds_write_b32 v30, v12 offset:20480
    ds_write_b32 v28, v13 offset:21260
    s_mov_b32 s31, 0
    s_mov_b32 s30, 2097152
L_srv:
    ds_read_b32 v12, v28 offset:21248
    s_waitcnt lgkmcnt(0)
    v_readfirstlane_b32 s67, v12
    s_add_u32 s67, s67, 3
    s_cmp_gt_u32 s67, s31
    s_cbranch_scc1 L_srv_req
    s_sleep 1
    s_sub_u32 s30, s30, 1
    s_cmp_lg_u32 s30, 0
    s_cbranch_scc1 L_srv
    s_branch L_srv_done
L_srv_req:
    s_sub_u32 s67, s67, s31
    s_min_u32 s67, s67, 32
    v_mov_b32 v12, s67
    buffer_atomic_add v12, v29, s[56:59], s69 offen sc0
    s_lshl_b32 s68, s31, 2
    v_add_u32 v14, s68, v30
    s_mov_b32 s65, 429496730
    s_waitcnt vmcnt(0)
    v_readfirstlane_b32 s68, v12
    s_min_u32 s68, s68, 80
    s_nop 0
    v_add_u32 v12, s68, v0
    v_mul_hi_u32 v15, s65, v12
    v_mul_u32_u24 v13, 246, v15
    v_add_u32 v13, v13, v12
    v_add_u32 v13, 246, v13
    v_lshlrev_b32 v13, 12, v13
    s_sub_u32 s65, 80, s68
    s_min_u32 s65, s65, s67
    v_cmp_gt_u32 vcc, s65, v0
    s_and_saveexec_b64 s[74:75], vcc
    ds_write_b32 v14, v13 offset:21504
    s_mov_b64 exec, -1
    s_add_u32 s31, s31, s65
    s_add_u32 s68, s68, s67
    s_cmp_lt_u32 s68, 80
    s_cbranch_scc1 L_srv
L_srv_done:
    s_lshl_b32 s68, s31, 2
    v_add_u32 v14, s68, v30
    v_mov_b32 v13, 0x80000000
    s_mov_b64 exec, 15
    ds_write_b32 v14, v13 offset:21504
    ds_write_b32 v28, v13 offset:21264
    s_mov_b64 exec, -1
    s_waitcnt lgkmcnt(0)
    s_endpgm
.p2align 6
L_ft:
    s_barrier
    s_mov_b32 s60, s22
    s_mov_b32 s61, s23
    s_mov_b32 s62, 2048
    s_mov_b32 s63, 0x00020000
    s_mov_b32 s40, s12
    s_mov_b32 s41, s13
    s_mov_b32 s42, 8388608
    s_mov_b32 s43, 0x00020000
    s_mov_b32 s66, 2097152
    s_cmp_lg_u32 s3, 5
    s_cbranch_scc1 L_ft_t0
    s_mov_b32 s40, s20
    s_mov_b32 s41, s21
    s_mov_b32 s42, 7340032
    s_mov_b32 s43, 0x00020000
    s_mov_b32 s66, 2621440
L_ft_t0:
    v_lshlrev_b32 v31, 4, v2
    v_lshl_add_u32 v31, v1, 11, v31
    v_lshl_add_u32 v32, v2, 2, v1
    v_lshlrev_b32 v32, 2, v32
    v_and_b32 v12, 7, v2
    v_lshrrev_b32 v12, 1, v12
    v_and_b32 v13, 1, v2
    v_lshlrev_b32 v13, 4, v13
    v_mov_b32 v14, 0xffff
    v_lshlrev_b32 v14, v13, v14
    v_cmp_eq_u32 vcc, 0, v12
    s_nop 1
    v_cndmask_b32 v4, 0, v14, vcc
    v_cmp_eq_u32 vcc, 1, v12
    s_nop 1
    v_cndmask_b32 v5, 0, v14, vcc
    v_cmp_eq_u32 vcc, 2, v12
    s_nop 1
    v_cndmask_b32 v6, 0, v14, vcc
    v_cmp_eq_u32 vcc, 3, v12
    s_nop 1
    v_cndmask_b32 v7, 0, v14, vcc
    v_and_b32 v38, 1, v1
    v_lshlrev_b32 v38, 5, v38
    v_lshl_add_u32 v38, v2, 6, v38
    v_lshrrev_b32 v39, 1, v1
    v_lshl_add_u32 v35, v39, 4, v38
    v_lshrrev_b32 v38, 3, v0
    v_lshlrev_b32 v38, 10, v38
    v_lshl_add_u32 v36, v33, 1, v38
    s_add_u32 s77, s29, s28
    s_and_b32 s77, s77, 7
    s_cmp_eq_u32 s3, 5
    s_cselect_b32 s67, 1, 0
    s_add_u32 s77, s77, s67
    s_and_b32 s77, s77, 7
    s_lshl_b32 s67, s77, 15
    s_add_u32 s37, s66, s67
    s_lshl_b32 s67, s28, 10
    s_add_u32 s37, s37, s67
    s_lshl_b32 s67, s29, 15
    s_add_u32 s66, s66, s67
    s_lshr_b32 s67, s28, 2
    s_lshl_b32 s67, s67, 7
    s_add_u32 s66, s66, s67
    s_waitcnt vmcnt(0)
    v_add_u32 v24, 1, v24
    v_mov_b32 v9, v24
    v_mov_b32 v11, v24
    v_mov_b32 v17, v24
    v_mov_b32 v19, v24
    s_cmp_lg_u32 s3, 5
    s_cbranch_scc1 L_t
    s_mov_b32 s30, 2097152
L_lw_gc:
    ds_read_b32 v12, v28 offset:21256
    s_waitcnt lgkmcnt(0)
    v_readfirstlane_b32 s68, v12
    s_cmp_ge_u32 s68, 4
    s_cbranch_scc1 L_lwd_gc
    s_sleep 2
    s_sub_u32 s30, s30, 1
    s_cmp_lg_u32 s30, 0
    s_cbranch_scc1 L_lw_gc
L_lwd_gc:
    s_cmp_lg_u32 s3, 5
    s_cbranch_scc1 L_ft_load
    ds_read2st64_b32 v[48:49], v32 offset0:16 offset1:17
    ds_read2st64_b32 v[50:51], v32 offset0:18 offset1:19
    ds_read2st64_b32 v[52:53], v32 offset0:20 offset1:21
    ds_read2st64_b32 v[54:55], v32 offset0:22 offset1:23
    ds_read2st64_b32 v[64:65], v32 offset0:32 offset1:33
    ds_read2st64_b32 v[66:67], v32 offset0:34 offset1:35
    ds_read2st64_b32 v[68:69], v32 offset0:36 offset1:37
    ds_read2st64_b32 v[70:71], v32 offset0:38 offset1:39
    s_waitcnt lgkmcnt(0)
    v_add_f32 v8, v48, v50
    v_add_f32 v10, v49, v51
    v_add_f32 v8, v8, v52
    v_add_f32 v10, v10, v53
    v_add_f32 v8, v8, v54
    v_add_f32 v10, v10, v55
    v_add_f32 v16, v64, v66
    v_add_f32 v18, v65, v67
    v_add_f32 v16, v16, v68
    v_add_f32 v18, v18, v69
    v_add_f32 v16, v16, v70
    v_add_f32 v18, v18, v71
    s_add_u32 s67, s28, 13
    s_and_b32 s67, s67, 31
    s_lshl_b32 s67, s67, 3
    s_add_u32 s67, s67, s29
    s_lshl_b32 s67, s67, 11
    s_add_u32 s67, s67, 327680
    buffer_store_dwordx4 v[8:11], v3, s[56:59], s67 offen offset:0 sc1
    s_add_u32 s67, s28, 6
    s_and_b32 s67, s67, 31
    s_lshl_b32 s67, s67, 3
    s_add_u32 s67, s67, s29
    s_lshl_b32 s67, s67, 11
    s_add_u32 s67, s67, 327680
    buffer_store_dwordx4 v[16:19], v3, s[56:59], s67 offen offset:1024 sc1
L_ft_load:
    s_sleep 127
    v_mov_b32 v12, 0
    v_mov_b32 v13, 0
    s_waitcnt vmcnt(0)
    s_cmp_ge_u32 s28, 28
    s_cbranch_scc1 L_late
    s_lshl_b32 s36, s28, 9
    s_add_u32 s36, s36, 917504
    s_and_b32 s67, s28, 7
    s_cmp_eq_u32 s67, s29
    s_cbranch_scc1 L_hred
    s_sleep 127
    s_mov_b32 s30, 131072
L_poll_h:
    buffer_load_dwordx2 v[48:49], v26, s[56:59], s36 offen sc1
    s_waitcnt vmcnt(0)
    v_cmp_ne_u32 vcc, v49, v24
    s_cbranch_vccz L_polled_h
    s_sleep 64
    s_sub_u32 s30, s30, 1
    s_cmp_lg_u32 s30, 0
    s_cbranch_scc1 L_poll_h
L_polled_h:
    v_and_b32 v12, 0xffff, v48
    v_lshl_or_b32 v12, v12, 16, v12
    v_lshrrev_b32 v13, 16, v48
    v_lshl_or_b32 v13, v13, 16, v13
    s_branch L_late
L_hred:
    s_lshl_b32 s32, s28, 14
    s_add_u32 s32, s32, 327680
    s_add_u32 s33, s32, 4096
    s_add_u32 s34, s32, 8192
    s_add_u32 s35, s32, 12288
    s_mov_b32 s30, 131072
L_poll_g:
    buffer_load_dwordx4 v[48:51], v3, s[56:59], s32 offen offset:0 sc1
    buffer_load_dwordx4 v[52:55], v3, s[56:59], s32 offen offset:1024 sc1
    buffer_load_dwordx4 v[56:59], v3, s[56:59], s32 offen offset:2048 sc1
    buffer_load_dwordx4 v[60:63], v3, s[56:59], s32 offen offset:3072 sc1
    buffer_load_dwordx4 v[64:67], v3, s[56:59], s33 offen offset:0 sc1
    buffer_load_dwordx4 v[68:71], v3, s[56:59], s33 offen offset:1024 sc1
    buffer_load_dwordx4 v[72:75], v3, s[56:59], s33 offen offset:2048 sc1
    buffer_load_dwordx4 v[76:79], v3, s[56:59], s33 offen offset:3072 sc1
    buffer_load_dwordx4 v[80:83], v3, s[56:59], s34 offen offset:0 sc1
    buffer_load_dwordx4 v[84:87], v3, s[56:59], s34 offen offset:1024 sc1
    buffer_load_dwordx4 v[88:91], v3, s[56:59], s34 offen offset:2048 sc1
    buffer_load_dwordx4 v[92:95], v3, s[56:59], s34 offen offset:3072 sc1
    buffer_load_dwordx4 v[96:99], v3, s[56:59], s35 offen offset:0 sc1
    buffer_load_dwordx4 v[100:103], v3, s[56:59], s35 offen offset:1024 sc1
    buffer_load_dwordx4 v[104:107], v3, s[56:59], s35 offen offset:2048 sc1
    buffer_load_dwordx4 v[108:111], v3, s[56:59], s35 offen offset:3072 sc1
    s_waitcnt vmcnt(0)
    v_xor_b32 v38, v49, v24
    v_xor_b32 v39, v51, v24
    v_or_b32 v27, v38, v39
    v_xor_b32 v38, v53, v24
    v_xor_b32 v39, v55, v24
    v_or3_b32 v27, v38, v39, v27
    v_xor_b32 v38, v57, v24
    v_xor_b32 v39, v59, v24
    v_or3_b32 v27, v38, v39, v27
    v_xor_b32 v38, v61, v24
    v_xor_b32 v39, v63, v24
    v_or3_b32 v27, v38, v39, v27
    v_xor_b32 v38, v65, v24
    v_xor_b32 v39, v67, v24
    v_or3_b32 v27, v38, v39, v27
    v_xor_b32 v38, v69, v24
    v_xor_b32 v39, v71, v24
    v_or3_b32 v27, v38, v39, v27
    v_xor_b32 v38, v73, v24
    v_xor_b32 v39, v75, v24
    v_or3_b32 v27, v38, v39, v27
    v_xor_b32 v38, v77, v24
    v_xor_b32 v39, v79, v24
    v_or3_b32 v27, v38, v39, v27
    v_xor_b32 v38, v81, v24
    v_xor_b32 v39, v83, v24
    v_or3_b32 v27, v38, v39, v27
    v_xor_b32 v38, v85, v24
    v_xor_b32 v39, v87, v24
    v_or3_b32 v27, v38, v39, v27
    v_xor_b32 v38, v89, v24
    v_xor_b32 v39, v91, v24
    v_or3_b32 v27, v38, v39, v27
    v_xor_b32 v38, v93, v24
    v_xor_b32 v39, v95, v24
    v_or3_b32 v27, v38, v39, v27
    v_xor_b32 v38, v97, v24
    v_xor_b32 v39, v99, v24
    v_or3_b32 v27, v38, v39, v27
    v_xor_b32 v38, v101, v24
    v_xor_b32 v39, v103, v24
    v_or3_b32 v27, v38, v39, v27
    v_xor_b32 v38, v105, v24
    v_xor_b32 v39, v107, v24
    v_or3_b32 v27, v38, v39, v27
    v_xor_b32 v38, v109, v24
    v_xor_b32 v39, v111, v24
    v_or3_b32 v27, v38, v39, v27
    v_cmp_ne_u32 vcc, 0, v27
    s_cbranch_vccz L_polled_g
    s_sleep 16
    s_sub_u32 s30, s30, 1
    s_cmp_lg_u32 s30, 0
    s_cbranch_scc1 L_poll_g
L_polled_g:
    v_add_f32 v20, v48, v56
    v_add_f32 v21, v50, v58
    v_add_f32 v20, v20, v64
    v_add_f32 v21, v21, v66
    v_add_f32 v20, v20, v72
    v_add_f32 v21, v21, v74
    v_add_f32 v20, v20, v80
    v_add_f32 v21, v21, v82
    v_add_f32 v20, v20, v88
    v_add_f32 v21, v21, v90
    v_add_f32 v20, v20, v96
    v_add_f32 v21, v21, v98
    v_add_f32 v20, v20, v104
    v_add_f32 v21, v21, v106
    v_add_f32 v22, v52, v60
    v_add_f32 v23, v54, v62
    v_add_f32 v22, v22, v68
    v_add_f32 v23, v23, v70
    v_add_f32 v22, v22, v76
    v_add_f32 v23, v23, v78
    v_add_f32 v22, v22, v84
    v_add_f32 v23, v23, v86
    v_add_f32 v22, v22, v92
    v_add_f32 v23, v23, v94
    v_add_f32 v22, v22, v100
    v_add_f32 v23, v23, v102
    v_add_f32 v22, v22, v108
    v_add_f32 v23, v23, v110
    v_cvt_pk_bf16_f32 v20, v20, v20
    v_and_b32 v20, 0xffff0000, v20
    v_cvt_pk_bf16_f32 v21, v21, v21
    v_and_b32 v21, 0xffff0000, v21
    v_cvt_pk_bf16_f32 v22, v22, v22
    v_and_b32 v22, 0xffff0000, v22
    v_cvt_pk_bf16_f32 v23, v23, v23
    v_and_b32 v23, 0xffff0000, v23
    v_mul_f32 v12, v20, v20
    v_mul_f32 v12, v12, v20
    v_mul_f32 v12, 0x3d372713, v12
    v_add_f32 v12, v12, v20
    v_mul_f32 v12, 0xc0135761, v12
    v_exp_f32 v12, v12
    s_nop 0
    v_add_f32 v12, 1.0, v12
    v_rcp_f32 v12, v12
    s_nop 0
    v_mul_f32 v12, v12, v20
    v_cvt_pk_bf16_f32 v12, v12, v12
    v_and_b32 v12, 0xffff0000, v12
    v_mul_f32 v12, v12, v22
    v_cvt_pk_bf16_f32 v12, v12, v12
    v_mul_f32 v13, v21, v21
    v_mul_f32 v13, v13, v21
    v_mul_f32 v13, 0x3d372713, v13
    v_add_f32 v13, v13, v21
    v_mul_f32 v13, 0xc0135761, v13
    v_exp_f32 v13, v13
    s_nop 0
    v_add_f32 v13, 1.0, v13
    v_rcp_f32 v13, v13
    s_nop 0
    v_mul_f32 v13, v13, v21
    v_cvt_pk_bf16_f32 v13, v13, v13
    v_and_b32 v13, 0xffff0000, v13
    v_mul_f32 v13, v13, v23
    v_cvt_pk_bf16_f32 v13, v13, v13
    v_and_b32 v8, 0xffff, v12
    v_lshl_or_b32 v8, v13, 16, v8
    buffer_store_dwordx2 v[8:9], v26, s[56:59], s36 offen sc1
    s_waitcnt vmcnt(0)
    s_branch L_late
L_t:
    s_lshl_b32 s32, s28, 14
    s_add_u32 s32, s32, 1048576
    s_add_u32 s33, s32, 4096
    s_add_u32 s34, s32, 8192
    s_add_u32 s35, s32, 12288
    s_lshl_b32 s36, s2, 11
    s_add_u32 s36, s36, 1048576
L_late:
    s_barrier
    s_cmp_lg_u32 s3, 5
    s_cbranch_scc1 L_t2
    s_mov_b32 s30, 2097152
L_lw_fo:
    ds_read_b32 v14, v28 offset:21256
    s_waitcnt lgkmcnt(0)
    v_readfirstlane_b32 s68, v14
    s_cmp_ge_u32 s68, 100
    s_cbranch_scc1 L_lwd_fo
    s_sleep 1
    s_sub_u32 s30, s30, 1
    s_cmp_lg_u32 s30, 0
    s_cbranch_scc1 L_lw_fo
L_lwd_fo:
    s_lshl_b32 s67, s28, 18
    s_lshl_b32 s68, s77, 8
    s_add_u32 s67, s67, s68
    buffer_load_dwordx4 v[112:115], v31, s[40:43], s67 offen nt
    s_add_u32 s67, s67, 8192
    buffer_load_dwordx4 v[116:119], v31, s[40:43], s67 offen nt
    s_add_u32 s67, s67, 8192
    buffer_load_dwordx4 v[120:123], v31, s[40:43], s67 offen nt
    s_add_u32 s67, s67, 8192
    buffer_load_dwordx4 v[124:127], v31, s[40:43], s67 offen nt
    s_add_u32 s67, s67, 8192
    buffer_load_dwordx4 v[128:131], v31, s[40:43], s67 offen nt
    s_add_u32 s67, s67, 8192
    buffer_load_dwordx4 v[132:135], v31, s[40:43], s67 offen nt
    s_add_u32 s67, s67, 8192
    buffer_load_dwordx4 v[136:139], v31, s[40:43], s67 offen nt
    s_add_u32 s67, s67, 8192
    buffer_load_dwordx4 v[140:143], v31, s[40:43], s67 offen nt
    s_add_u32 s67, s67, 8192
    buffer_load_dwordx4 v[144:147], v31, s[40:43], s67 offen nt
    s_add_u32 s67, s67, 8192
    buffer_load_dwordx4 v[148:151], v31, s[40:43], s67 offen nt
    s_add_u32 s67, s67, 8192
    buffer_load_dwordx4 v[152:155], v31, s[40:43], s67 offen nt
    s_add_u32 s67, s67, 8192
    buffer_load_dwordx4 v[156:159], v31, s[40:43], s67 offen nt
    s_add_u32 s67, s67, 8192
    buffer_load_dwordx4 v[160:163], v31, s[40:43], s67 offen nt
    s_add_u32 s67, s67, 8192
    buffer_load_dwordx4 v[164:167], v31, s[40:43], s67 offen nt
    s_add_u32 s67, s67, 8192
    buffer_load_dwordx4 v[168:171], v31, s[40:43], s67 offen nt
    s_add_u32 s67, s67, 8192
    buffer_load_dwordx4 v[172:175], v31, s[40:43], s67 offen nt
    s_add_u32 s67, s67, 8192
    buffer_load_dwordx4 v[176:179], v31, s[40:43], s67 offen nt
    s_add_u32 s67, s67, 8192
    buffer_load_dwordx4 v[180:183], v31, s[40:43], s67 offen nt
    s_add_u32 s67, s67, 8192
    buffer_load_dwordx4 v[184:187], v31, s[40:43], s67 offen nt
    s_add_u32 s67, s67, 8192
    buffer_load_dwordx4 v[188:191], v31, s[40:43], s67 offen nt
    s_add_u32 s67, s67, 8192
    buffer_load_dwordx4 v[192:195], v31, s[40:43], s67 offen nt
    s_add_u32 s67, s67, 8192
    buffer_load_dwordx4 v[196:199], v31, s[40:43], s67 offen nt
    s_add_u32 s67, s67, 8192
    buffer_load_dwordx4 v[200:203], v31, s[40:43], s67 offen nt
    s_add_u32 s67, s67, 8192
    buffer_load_dwordx4 v[204:207], v31, s[40:43], s67 offen nt
    s_add_u32 s67, s67, 8192
    buffer_load_dwordx4 v[208:211], v31, s[40:43], s67 offen nt
    s_add_u32 s67, s67, 8192
    buffer_load_dwordx4 v[212:215], v31, s[40:43], s67 offen nt
    s_add_u32 s67, s67, 8192
    buffer_load_dwordx4 v[216:219], v31, s[40:43], s67 offen nt
    s_add_u32 s67, s67, 8192
    buffer_load_dwordx4 v[220:223], v31, s[40:43], s67 offen nt
    s_add_u32 s67, s67, 8192
    buffer_load_dwordx4 v[224:227], v31, s[40:43], s67 offen nt
    s_add_u32 s67, s67, 8192
    buffer_load_dwordx4 v[228:231], v31, s[40:43], s67 offen nt
    s_add_u32 s67, s67, 8192
    buffer_load_dwordx4 v[232:235], v31, s[40:43], s67 offen nt
    s_add_u32 s67, s67, 8192
    buffer_load_dwordx4 v[236:239], v31, s[40:43], s67 offen nt
    s_branch L_mv
L_t2:
    ds_read_b64 v[12:13], v33 offset:20992
    ds_read2st64_b32 v[48:49], v32 offset0:48 offset1:49
    ds_read2st64_b32 v[50:51], v32 offset0:50 offset1:51
    ds_read2st64_b32 v[52:53], v32 offset0:52 offset1:53
    ds_read_b64 v[88:89], v33 offset:21312
    s_waitcnt lgkmcnt(0)
    v_min_f32_dpp v16, v12, v12 quad_perm:[1,0,3,2] row_mask:0xf bank_mask:0xf
    s_nop 1
    v_min_f32_dpp v16, v16, v16 quad_perm:[2,3,0,1] row_mask:0xf bank_mask:0xf
    s_nop 1
    v_min_f32_dpp v16, v16, v16 row_half_mirror row_mask:0xf bank_mask:0xf
    v_sub_f32 v12, v16, v12
    v_exp_f32 v12, v12
    s_nop 0
    v_mul_f32 v18, v13, v12
    v_mul_f32_dpp v8, v12, v48 row_newbcast:0 row_mask:0xf bank_mask:0xf
    v_mul_f32_dpp v10, v12, v49 row_newbcast:0 row_mask:0xf bank_mask:0xf
    s_nop 0
    v_fmac_f32_dpp v8, v12, v50 row_newbcast:1 row_mask:0xf bank_mask:0xf
    v_fmac_f32_dpp v10, v12, v51 row_newbcast:1 row_mask:0xf bank_mask:0xf
    s_nop 0
    v_fmac_f32_dpp v8, v12, v52 row_newbcast:2 row_mask:0xf bank_mask:0xf
    v_fmac_f32_dpp v10, v12, v53 row_newbcast:2 row_mask:0xf bank_mask:0xf
    v_add_f32_dpp v18, v18, v18 quad_perm:[1,0,3,2] row_mask:0xf bank_mask:0xf
    s_nop 1
    v_add_f32_dpp v18, v18, v18 quad_perm:[2,3,0,1] row_mask:0xf bank_mask:0xf
    s_nop 1
    v_add_f32_dpp v18, v18, v18 row_half_mirror row_mask:0xf bank_mask:0xf
    buffer_store_dwordx4 v[8:11], v3, s[56:59], s36 offen sc1
    buffer_store_dwordx4 v[16:19], v29, s[56:59], s36 offen offset:1024 sc1
    s_lshl_b32 s67, s28, 18
    s_lshl_b32 s68, s77, 8
    s_add_u32 s67, s67, s68
    v_mov_b32 v39, 100
    buffer_load_dwordx4 v[112:115], v31, s[40:43], s67 offen nt
    s_add_u32 s67, s67, 8192
    buffer_load_dwordx4 v[116:119], v31, s[40:43], s67 offen nt
    s_add_u32 s67, s67, 8192
    buffer_load_dwordx4 v[120:123], v31, s[40:43], s67 offen nt
    s_add_u32 s67, s67, 8192
    buffer_load_dwordx4 v[124:127], v31, s[40:43], s67 offen nt
    s_add_u32 s67, s67, 8192
    buffer_load_dwordx4 v[128:131], v31, s[40:43], s67 offen nt
    s_add_u32 s67, s67, 8192
    buffer_load_dwordx4 v[132:135], v31, s[40:43], s67 offen nt
    s_add_u32 s67, s67, 8192
    buffer_load_dwordx4 v[136:139], v31, s[40:43], s67 offen nt
    s_add_u32 s67, s67, 8192
    buffer_load_dwordx4 v[140:143], v31, s[40:43], s67 offen nt
    s_add_u32 s67, s67, 8192
    buffer_load_dwordx4 v[144:147], v31, s[40:43], s67 offen nt
    s_add_u32 s67, s67, 8192
    buffer_load_dwordx4 v[148:151], v31, s[40:43], s67 offen nt
    s_add_u32 s67, s67, 8192
    buffer_load_dwordx4 v[152:155], v31, s[40:43], s67 offen nt
    s_add_u32 s67, s67, 8192
    buffer_load_dwordx4 v[156:159], v31, s[40:43], s67 offen nt
    s_add_u32 s67, s67, 8192
    buffer_load_dwordx4 v[160:163], v31, s[40:43], s67 offen nt
    s_add_u32 s67, s67, 8192
    buffer_load_dwordx4 v[164:167], v31, s[40:43], s67 offen nt
    s_add_u32 s67, s67, 8192
    buffer_load_dwordx4 v[168:171], v31, s[40:43], s67 offen nt
    s_add_u32 s67, s67, 8192
    buffer_load_dwordx4 v[172:175], v31, s[40:43], s67 offen nt
    s_add_u32 s67, s67, 8192
    buffer_load_dwordx4 v[176:179], v31, s[40:43], s67 offen nt
    s_add_u32 s67, s67, 8192
    buffer_load_dwordx4 v[180:183], v31, s[40:43], s67 offen nt
    s_add_u32 s67, s67, 8192
    buffer_load_dwordx4 v[184:187], v31, s[40:43], s67 offen nt
    s_add_u32 s67, s67, 8192
    buffer_load_dwordx4 v[188:191], v31, s[40:43], s67 offen nt
    s_add_u32 s67, s67, 8192
    buffer_load_dwordx4 v[192:195], v31, s[40:43], s67 offen nt
    s_add_u32 s67, s67, 8192
    buffer_load_dwordx4 v[196:199], v31, s[40:43], s67 offen nt
    s_add_u32 s67, s67, 8192
    buffer_load_dwordx4 v[200:203], v31, s[40:43], s67 offen nt
    s_add_u32 s67, s67, 8192
    buffer_load_dwordx4 v[204:207], v31, s[40:43], s67 offen nt
    s_add_u32 s67, s67, 8192
    buffer_load_dwordx4 v[208:211], v31, s[40:43], s67 offen nt
    s_add_u32 s67, s67, 8192
    buffer_load_dwordx4 v[212:215], v31, s[40:43], s67 offen nt
    s_add_u32 s67, s67, 8192
    buffer_load_dwordx4 v[216:219], v31, s[40:43], s67 offen nt
    s_add_u32 s67, s67, 8192
    buffer_load_dwordx4 v[220:223], v31, s[40:43], s67 offen nt
    s_add_u32 s67, s67, 8192
    buffer_load_dwordx4 v[224:227], v31, s[40:43], s67 offen nt
    s_add_u32 s67, s67, 8192
    buffer_load_dwordx4 v[228:231], v31, s[40:43], s67 offen nt
    s_add_u32 s67, s67, 8192
    buffer_load_dwordx4 v[232:235], v31, s[40:43], s67 offen nt
    s_add_u32 s67, s67, 8192
    ds_write_b32 v28, v39 offset:21256
    buffer_load_dwordx4 v[236:239], v31, s[40:43], s67 offen nt
    s_mov_b32 s30, 131072
L_poll_a:
    buffer_load_dwordx4 v[48:51], v3, s[56:59], s32 offen offset:0 sc1
    buffer_load_dwordx4 v[52:55], v3, s[56:59], s32 offen offset:2048 sc1
    buffer_load_dwordx4 v[56:59], v3, s[56:59], s33 offen offset:0 sc1
    buffer_load_dwordx4 v[60:63], v3, s[56:59], s33 offen offset:2048 sc1
    buffer_load_dwordx4 v[64:67], v3, s[56:59], s34 offen offset:0 sc1
    buffer_load_dwordx4 v[68:71], v3, s[56:59], s34 offen offset:2048 sc1
    buffer_load_dwordx4 v[72:75], v3, s[56:59], s35 offen offset:0 sc1
    buffer_load_dwordx4 v[76:79], v3, s[56:59], s35 offen offset:2048 sc1
    buffer_load_dwordx4 v[80:83], v34, s[56:59], s32 offen offset:1024 sc1
    s_waitcnt vmcnt(0)
    v_xor_b32 v38, v49, v24
    v_xor_b32 v39, v51, v24
    v_or_b32 v27, v38, v39
    v_xor_b32 v38, v53, v24
    v_xor_b32 v39, v55, v24
    v_or3_b32 v27, v38, v39, v27
    v_xor_b32 v38, v57, v24
    v_xor_b32 v39, v59, v24
    v_or3_b32 v27, v38, v39, v27
    v_xor_b32 v38, v61, v24
    v_xor_b32 v39, v63, v24
    v_or3_b32 v27, v38, v39, v27
    v_xor_b32 v38, v65, v24
    v_xor_b32 v39, v67, v24
    v_or3_b32 v27, v38, v39, v27
    v_xor_b32 v38, v69, v24
    v_xor_b32 v39, v71, v24
    v_or3_b32 v27, v38, v39, v27
    v_xor_b32 v38, v73, v24
    v_xor_b32 v39, v75, v24
    v_or3_b32 v27, v38, v39, v27
    v_xor_b32 v38, v77, v24
    v_xor_b32 v39, v79, v24
    v_or3_b32 v27, v38, v39, v27
    v_xor_b32 v38, v81, v24
    v_xor_b32 v39, v83, v24
    v_or3_b32 v27, v38, v39, v27
    v_cmp_ne_u32 vcc, 0, v27
    s_cbranch_vccz L_polled_a
    s_sleep 1
    s_sub_u32 s30, s30, 1
    s_cmp_lg_u32 s30, 0
    s_cbranch_scc1 L_poll_a
L_polled_a:
    v_min_f32_dpp v14, v80, v80 quad_perm:[1,0,3,2] row_mask:0xf bank_mask:0xf
    s_nop 1
    v_min_f32_dpp v14, v14, v14 quad_perm:[2,3,0,1] row_mask:0xf bank_mask:0xf
    s_nop 1
    v_min_f32_dpp v14, v14, v14 row_half_mirror row_mask:0xf bank_mask:0xf
    v_sub_f32 v80, v14, v80
    v_exp_f32 v80, v80
    s_nop 0
    v_mul_f32 v15, v82, v80
    v_mul_f32_dpp v12, v80, v48 row_newbcast:0 row_mask:0xf bank_mask:0xf
    v_mul_f32_dpp v13, v80, v50 row_newbcast:0 row_mask:0xf bank_mask:0xf
    s_nop 0
    v_fmac_f32_dpp v12, v80, v52 row_newbcast:1 row_mask:0xf bank_mask:0xf
    v_fmac_f32_dpp v13, v80, v54 row_newbcast:1 row_mask:0xf bank_mask:0xf
    s_nop 0
    v_fmac_f32_dpp v12, v80, v56 row_newbcast:2 row_mask:0xf bank_mask:0xf
    v_fmac_f32_dpp v13, v80, v58 row_newbcast:2 row_mask:0xf bank_mask:0xf
    s_nop 0
    v_fmac_f32_dpp v12, v80, v60 row_newbcast:3 row_mask:0xf bank_mask:0xf
    v_fmac_f32_dpp v13, v80, v62 row_newbcast:3 row_mask:0xf bank_mask:0xf
    s_nop 0
    v_fmac_f32_dpp v12, v80, v64 row_newbcast:4 row_mask:0xf bank_mask:0xf
    v_fmac_f32_dpp v13, v80, v66 row_newbcast:4 row_mask:0xf bank_mask:0xf
    s_nop 0
    v_fmac_f32_dpp v12, v80, v68 row_newbcast:5 row_mask:0xf bank_mask:0xf
    v_fmac_f32_dpp v13, v80, v70 row_newbcast:5 row_mask:0xf bank_mask:0xf
    s_nop 0
    v_fmac_f32_dpp v12, v80, v72 row_newbcast:6 row_mask:0xf bank_mask:0xf
    v_fmac_f32_dpp v13, v80, v74 row_newbcast:6 row_mask:0xf bank_mask:0xf
    s_nop 0
    v_fmac_f32_dpp v12, v80, v76 row_newbcast:7 row_mask:0xf bank_mask:0xf
    v_fmac_f32_dpp v13, v80, v78 row_newbcast:7 row_mask:0xf bank_mask:0xf
    v_add_f32_dpp v15, v15, v15 quad_perm:[1,0,3,2] row_mask:0xf bank_mask:0xf
    s_nop 1
    v_add_f32_dpp v15, v15, v15 quad_perm:[2,3,0,1] row_mask:0xf bank_mask:0xf
    s_nop 1
    v_add_f32_dpp v15, v15, v15 row_half_mirror row_mask:0xf bank_mask:0xf
    v_rcp_f32 v15, v15
    s_nop 0
    v_mul_f32 v12, v12, v15
    v_mul_f32 v13, v13, v15
    v_cvt_pk_bf16_f32 v12, v12, v12
    v_cvt_pk_bf16_f32 v13, v13, v13
L_mv:
    s_nop 1
    v_and_b32_dpp v40, v12, v4 row_newbcast:0 row_mask:0xf bank_mask:0xf
    v_and_b32_dpp v41, v12, v5 row_newbcast:0 row_mask:0xf bank_mask:0xf
    v_and_b32_dpp v42, v12, v6 row_newbcast:0 row_mask:0xf bank_mask:0xf
    v_and_b32_dpp v43, v12, v7 row_newbcast:0 row_mask:0xf bank_mask:0xf
    v_and_b32_dpp v44, v12, v4 row_newbcast:1 row_mask:0xf bank_mask:0xf
    v_and_b32_dpp v45, v12, v5 row_newbcast:1 row_mask:0xf bank_mask:0xf
    v_and_b32_dpp v46, v12, v6 row_newbcast:1 row_mask:0xf bank_mask:0xf
    v_and_b32_dpp v47, v12, v7 row_newbcast:1 row_mask:0xf bank_mask:0xf
    s_waitcnt vmcnt(30)
    v_mfma_f32_16x16x32_bf16 v[20:23], v[40:43], v[112:115], 0
    v_and_b32_dpp v40, v12, v4 row_newbcast:2 row_mask:0xf bank_mask:0xf
    v_and_b32_dpp v41, v12, v5 row_newbcast:2 row_mask:0xf bank_mask:0xf
    v_and_b32_dpp v42, v12, v6 row_newbcast:2 row_mask:0xf bank_mask:0xf
    v_and_b32_dpp v43, v12, v7 row_newbcast:2 row_mask:0xf bank_mask:0xf
    v_mfma_f32_16x16x32_bf16 v[20:23], v[44:47], v[116:119], v[20:23]
    v_and_b32_dpp v44, v12, v4 row_newbcast:3 row_mask:0xf bank_mask:0xf
    v_and_b32_dpp v45, v12, v5 row_newbcast:3 row_mask:0xf bank_mask:0xf
    v_and_b32_dpp v46, v12, v6 row_newbcast:3 row_mask:0xf bank_mask:0xf
    v_and_b32_dpp v47, v12, v7 row_newbcast:3 row_mask:0xf bank_mask:0xf
    s_waitcnt vmcnt(28)
    v_mfma_f32_16x16x32_bf16 v[20:23], v[40:43], v[120:123], v[20:23]
    v_and_b32_dpp v40, v12, v4 row_newbcast:4 row_mask:0xf bank_mask:0xf
    v_and_b32_dpp v41, v12, v5 row_newbcast:4 row_mask:0xf bank_mask:0xf
    v_and_b32_dpp v42, v12, v6 row_newbcast:4 row_mask:0xf bank_mask:0xf
    v_and_b32_dpp v43, v12, v7 row_newbcast:4 row_mask:0xf bank_mask:0xf
    v_mfma_f32_16x16x32_bf16 v[20:23], v[44:47], v[124:127], v[20:23]
    v_and_b32_dpp v44, v12, v4 row_newbcast:5 row_mask:0xf bank_mask:0xf
    v_and_b32_dpp v45, v12, v5 row_newbcast:5 row_mask:0xf bank_mask:0xf
    v_and_b32_dpp v46, v12, v6 row_newbcast:5 row_mask:0xf bank_mask:0xf
    v_and_b32_dpp v47, v12, v7 row_newbcast:5 row_mask:0xf bank_mask:0xf
    s_waitcnt vmcnt(26)
    v_mfma_f32_16x16x32_bf16 v[20:23], v[40:43], v[128:131], v[20:23]
    v_and_b32_dpp v40, v12, v4 row_newbcast:6 row_mask:0xf bank_mask:0xf
    v_and_b32_dpp v41, v12, v5 row_newbcast:6 row_mask:0xf bank_mask:0xf
    v_and_b32_dpp v42, v12, v6 row_newbcast:6 row_mask:0xf bank_mask:0xf
    v_and_b32_dpp v43, v12, v7 row_newbcast:6 row_mask:0xf bank_mask:0xf
    v_mfma_f32_16x16x32_bf16 v[20:23], v[44:47], v[132:135], v[20:23]
    v_and_b32_dpp v44, v12, v4 row_newbcast:7 row_mask:0xf bank_mask:0xf
    v_and_b32_dpp v45, v12, v5 row_newbcast:7 row_mask:0xf bank_mask:0xf
    v_and_b32_dpp v46, v12, v6 row_newbcast:7 row_mask:0xf bank_mask:0xf
    v_and_b32_dpp v47, v12, v7 row_newbcast:7 row_mask:0xf bank_mask:0xf
    s_waitcnt vmcnt(24)
    v_mfma_f32_16x16x32_bf16 v[20:23], v[40:43], v[136:139], v[20:23]
    v_and_b32_dpp v40, v12, v4 row_newbcast:8 row_mask:0xf bank_mask:0xf
    v_and_b32_dpp v41, v12, v5 row_newbcast:8 row_mask:0xf bank_mask:0xf
    v_and_b32_dpp v42, v12, v6 row_newbcast:8 row_mask:0xf bank_mask:0xf
    v_and_b32_dpp v43, v12, v7 row_newbcast:8 row_mask:0xf bank_mask:0xf
    v_mfma_f32_16x16x32_bf16 v[20:23], v[44:47], v[140:143], v[20:23]
    v_and_b32_dpp v44, v12, v4 row_newbcast:9 row_mask:0xf bank_mask:0xf
    v_and_b32_dpp v45, v12, v5 row_newbcast:9 row_mask:0xf bank_mask:0xf
    v_and_b32_dpp v46, v12, v6 row_newbcast:9 row_mask:0xf bank_mask:0xf
    v_and_b32_dpp v47, v12, v7 row_newbcast:9 row_mask:0xf bank_mask:0xf
    s_waitcnt vmcnt(22)
    v_mfma_f32_16x16x32_bf16 v[20:23], v[40:43], v[144:147], v[20:23]
    v_and_b32_dpp v40, v12, v4 row_newbcast:10 row_mask:0xf bank_mask:0xf
    v_and_b32_dpp v41, v12, v5 row_newbcast:10 row_mask:0xf bank_mask:0xf
    v_and_b32_dpp v42, v12, v6 row_newbcast:10 row_mask:0xf bank_mask:0xf
    v_and_b32_dpp v43, v12, v7 row_newbcast:10 row_mask:0xf bank_mask:0xf
    v_mfma_f32_16x16x32_bf16 v[20:23], v[44:47], v[148:151], v[20:23]
    v_and_b32_dpp v44, v12, v4 row_newbcast:11 row_mask:0xf bank_mask:0xf
    v_and_b32_dpp v45, v12, v5 row_newbcast:11 row_mask:0xf bank_mask:0xf
    v_and_b32_dpp v46, v12, v6 row_newbcast:11 row_mask:0xf bank_mask:0xf
    v_and_b32_dpp v47, v12, v7 row_newbcast:11 row_mask:0xf bank_mask:0xf
    s_waitcnt vmcnt(20)
    v_mfma_f32_16x16x32_bf16 v[20:23], v[40:43], v[152:155], v[20:23]
    v_and_b32_dpp v40, v12, v4 row_newbcast:12 row_mask:0xf bank_mask:0xf
    v_and_b32_dpp v41, v12, v5 row_newbcast:12 row_mask:0xf bank_mask:0xf
    v_and_b32_dpp v42, v12, v6 row_newbcast:12 row_mask:0xf bank_mask:0xf
    v_and_b32_dpp v43, v12, v7 row_newbcast:12 row_mask:0xf bank_mask:0xf
    v_mfma_f32_16x16x32_bf16 v[20:23], v[44:47], v[156:159], v[20:23]
    v_and_b32_dpp v44, v12, v4 row_newbcast:13 row_mask:0xf bank_mask:0xf
    v_and_b32_dpp v45, v12, v5 row_newbcast:13 row_mask:0xf bank_mask:0xf
    v_and_b32_dpp v46, v12, v6 row_newbcast:13 row_mask:0xf bank_mask:0xf
    v_and_b32_dpp v47, v12, v7 row_newbcast:13 row_mask:0xf bank_mask:0xf
    s_waitcnt vmcnt(18)
    v_mfma_f32_16x16x32_bf16 v[20:23], v[40:43], v[160:163], v[20:23]
    v_and_b32_dpp v40, v12, v4 row_newbcast:14 row_mask:0xf bank_mask:0xf
    v_and_b32_dpp v41, v12, v5 row_newbcast:14 row_mask:0xf bank_mask:0xf
    v_and_b32_dpp v42, v12, v6 row_newbcast:14 row_mask:0xf bank_mask:0xf
    v_and_b32_dpp v43, v12, v7 row_newbcast:14 row_mask:0xf bank_mask:0xf
    v_mfma_f32_16x16x32_bf16 v[20:23], v[44:47], v[164:167], v[20:23]
    v_and_b32_dpp v44, v12, v4 row_newbcast:15 row_mask:0xf bank_mask:0xf
    v_and_b32_dpp v45, v12, v5 row_newbcast:15 row_mask:0xf bank_mask:0xf
    v_and_b32_dpp v46, v12, v6 row_newbcast:15 row_mask:0xf bank_mask:0xf
    v_and_b32_dpp v47, v12, v7 row_newbcast:15 row_mask:0xf bank_mask:0xf
    s_waitcnt vmcnt(16)
    v_mfma_f32_16x16x32_bf16 v[20:23], v[40:43], v[168:171], v[20:23]
    v_and_b32_dpp v40, v13, v4 row_newbcast:0 row_mask:0xf bank_mask:0xf
    v_and_b32_dpp v41, v13, v5 row_newbcast:0 row_mask:0xf bank_mask:0xf
    v_and_b32_dpp v42, v13, v6 row_newbcast:0 row_mask:0xf bank_mask:0xf
    v_and_b32_dpp v43, v13, v7 row_newbcast:0 row_mask:0xf bank_mask:0xf
    v_mfma_f32_16x16x32_bf16 v[20:23], v[44:47], v[172:175], v[20:23]
    v_and_b32_dpp v44, v13, v4 row_newbcast:1 row_mask:0xf bank_mask:0xf
    v_and_b32_dpp v45, v13, v5 row_newbcast:1 row_mask:0xf bank_mask:0xf
    v_and_b32_dpp v46, v13, v6 row_newbcast:1 row_mask:0xf bank_mask:0xf
    v_and_b32_dpp v47, v13, v7 row_newbcast:1 row_mask:0xf bank_mask:0xf
    s_waitcnt vmcnt(14)
    v_mfma_f32_16x16x32_bf16 v[20:23], v[40:43], v[176:179], v[20:23]
    v_and_b32_dpp v40, v13, v4 row_newbcast:2 row_mask:0xf bank_mask:0xf
    v_and_b32_dpp v41, v13, v5 row_newbcast:2 row_mask:0xf bank_mask:0xf
    v_and_b32_dpp v42, v13, v6 row_newbcast:2 row_mask:0xf bank_mask:0xf
    v_and_b32_dpp v43, v13, v7 row_newbcast:2 row_mask:0xf bank_mask:0xf
    v_mfma_f32_16x16x32_bf16 v[20:23], v[44:47], v[180:183], v[20:23]
    v_and_b32_dpp v44, v13, v4 row_newbcast:3 row_mask:0xf bank_mask:0xf
    v_and_b32_dpp v45, v13, v5 row_newbcast:3 row_mask:0xf bank_mask:0xf
    v_and_b32_dpp v46, v13, v6 row_newbcast:3 row_mask:0xf bank_mask:0xf
    v_and_b32_dpp v47, v13, v7 row_newbcast:3 row_mask:0xf bank_mask:0xf
    s_waitcnt vmcnt(12)
    v_mfma_f32_16x16x32_bf16 v[20:23], v[40:43], v[184:187], v[20:23]
    v_and_b32_dpp v40, v13, v4 row_newbcast:4 row_mask:0xf bank_mask:0xf
    v_and_b32_dpp v41, v13, v5 row_newbcast:4 row_mask:0xf bank_mask:0xf
    v_and_b32_dpp v42, v13, v6 row_newbcast:4 row_mask:0xf bank_mask:0xf
    v_and_b32_dpp v43, v13, v7 row_newbcast:4 row_mask:0xf bank_mask:0xf
    v_mfma_f32_16x16x32_bf16 v[20:23], v[44:47], v[188:191], v[20:23]
    v_and_b32_dpp v44, v13, v4 row_newbcast:5 row_mask:0xf bank_mask:0xf
    v_and_b32_dpp v45, v13, v5 row_newbcast:5 row_mask:0xf bank_mask:0xf
    v_and_b32_dpp v46, v13, v6 row_newbcast:5 row_mask:0xf bank_mask:0xf
    v_and_b32_dpp v47, v13, v7 row_newbcast:5 row_mask:0xf bank_mask:0xf
    s_waitcnt vmcnt(10)
    v_mfma_f32_16x16x32_bf16 v[20:23], v[40:43], v[192:195], v[20:23]
    v_and_b32_dpp v40, v13, v4 row_newbcast:6 row_mask:0xf bank_mask:0xf
    v_and_b32_dpp v41, v13, v5 row_newbcast:6 row_mask:0xf bank_mask:0xf
    v_and_b32_dpp v42, v13, v6 row_newbcast:6 row_mask:0xf bank_mask:0xf
    v_and_b32_dpp v43, v13, v7 row_newbcast:6 row_mask:0xf bank_mask:0xf
    v_mfma_f32_16x16x32_bf16 v[20:23], v[44:47], v[196:199], v[20:23]
    v_and_b32_dpp v44, v13, v4 row_newbcast:7 row_mask:0xf bank_mask:0xf
    v_and_b32_dpp v45, v13, v5 row_newbcast:7 row_mask:0xf bank_mask:0xf
    v_and_b32_dpp v46, v13, v6 row_newbcast:7 row_mask:0xf bank_mask:0xf
    v_and_b32_dpp v47, v13, v7 row_newbcast:7 row_mask:0xf bank_mask:0xf
    s_waitcnt vmcnt(8)
    v_mfma_f32_16x16x32_bf16 v[20:23], v[40:43], v[200:203], v[20:23]
    v_and_b32_dpp v40, v13, v4 row_newbcast:8 row_mask:0xf bank_mask:0xf
    v_and_b32_dpp v41, v13, v5 row_newbcast:8 row_mask:0xf bank_mask:0xf
    v_and_b32_dpp v42, v13, v6 row_newbcast:8 row_mask:0xf bank_mask:0xf
    v_and_b32_dpp v43, v13, v7 row_newbcast:8 row_mask:0xf bank_mask:0xf
    v_mfma_f32_16x16x32_bf16 v[20:23], v[44:47], v[204:207], v[20:23]
    v_and_b32_dpp v44, v13, v4 row_newbcast:9 row_mask:0xf bank_mask:0xf
    v_and_b32_dpp v45, v13, v5 row_newbcast:9 row_mask:0xf bank_mask:0xf
    v_and_b32_dpp v46, v13, v6 row_newbcast:9 row_mask:0xf bank_mask:0xf
    v_and_b32_dpp v47, v13, v7 row_newbcast:9 row_mask:0xf bank_mask:0xf
    s_waitcnt vmcnt(6)
    v_mfma_f32_16x16x32_bf16 v[20:23], v[40:43], v[208:211], v[20:23]
    v_and_b32_dpp v40, v13, v4 row_newbcast:10 row_mask:0xf bank_mask:0xf
    v_and_b32_dpp v41, v13, v5 row_newbcast:10 row_mask:0xf bank_mask:0xf
    v_and_b32_dpp v42, v13, v6 row_newbcast:10 row_mask:0xf bank_mask:0xf
    v_and_b32_dpp v43, v13, v7 row_newbcast:10 row_mask:0xf bank_mask:0xf
    v_mfma_f32_16x16x32_bf16 v[20:23], v[44:47], v[212:215], v[20:23]
    v_and_b32_dpp v44, v13, v4 row_newbcast:11 row_mask:0xf bank_mask:0xf
    v_and_b32_dpp v45, v13, v5 row_newbcast:11 row_mask:0xf bank_mask:0xf
    v_and_b32_dpp v46, v13, v6 row_newbcast:11 row_mask:0xf bank_mask:0xf
    v_and_b32_dpp v47, v13, v7 row_newbcast:11 row_mask:0xf bank_mask:0xf
    s_waitcnt vmcnt(4)
    v_mfma_f32_16x16x32_bf16 v[20:23], v[40:43], v[216:219], v[20:23]
    v_and_b32_dpp v40, v13, v4 row_newbcast:12 row_mask:0xf bank_mask:0xf
    v_and_b32_dpp v41, v13, v5 row_newbcast:12 row_mask:0xf bank_mask:0xf
    v_and_b32_dpp v42, v13, v6 row_newbcast:12 row_mask:0xf bank_mask:0xf
    v_and_b32_dpp v43, v13, v7 row_newbcast:12 row_mask:0xf bank_mask:0xf
    v_mfma_f32_16x16x32_bf16 v[20:23], v[44:47], v[220:223], v[20:23]
    v_and_b32_dpp v44, v13, v4 row_newbcast:13 row_mask:0xf bank_mask:0xf
    v_and_b32_dpp v45, v13, v5 row_newbcast:13 row_mask:0xf bank_mask:0xf
    v_and_b32_dpp v46, v13, v6 row_newbcast:13 row_mask:0xf bank_mask:0xf
    v_and_b32_dpp v47, v13, v7 row_newbcast:13 row_mask:0xf bank_mask:0xf
    s_waitcnt vmcnt(2)
    v_mfma_f32_16x16x32_bf16 v[20:23], v[40:43], v[224:227], v[20:23]
    v_and_b32_dpp v40, v13, v4 row_newbcast:14 row_mask:0xf bank_mask:0xf
    v_and_b32_dpp v41, v13, v5 row_newbcast:14 row_mask:0xf bank_mask:0xf
    v_and_b32_dpp v42, v13, v6 row_newbcast:14 row_mask:0xf bank_mask:0xf
    v_and_b32_dpp v43, v13, v7 row_newbcast:14 row_mask:0xf bank_mask:0xf
    v_mfma_f32_16x16x32_bf16 v[20:23], v[44:47], v[228:231], v[20:23]
    v_and_b32_dpp v44, v13, v4 row_newbcast:15 row_mask:0xf bank_mask:0xf
    v_and_b32_dpp v45, v13, v5 row_newbcast:15 row_mask:0xf bank_mask:0xf
    v_and_b32_dpp v46, v13, v6 row_newbcast:15 row_mask:0xf bank_mask:0xf
    v_and_b32_dpp v47, v13, v7 row_newbcast:15 row_mask:0xf bank_mask:0xf
    s_waitcnt vmcnt(0)
    v_mfma_f32_16x16x32_bf16 v[20:23], v[40:43], v[232:235], v[20:23]
    v_mfma_f32_16x16x32_bf16 v[20:23], v[44:47], v[236:239], v[20:23]
    v_cmp_gt_u32 vcc, 32, v0
    s_add_u32 s32, s66, 0
    s_add_u32 s33, s66, 8192
    s_add_u32 s34, s66, 16384
    s_add_u32 s35, s66, 24576
    s_nop 2
    v_cndmask_b32 v8, v22, v20, vcc
    v_cndmask_b32 v10, v23, v21, vcc
    buffer_store_dwordx4 v[8:11], v35, s[56:59], s37 offen sc1
    s_and_b32 s67, s28, 3
    s_cmp_lg_u32 s67, 0
    s_cbranch_scc1 L_hexit
    s_cmp_eq_u32 s3, 5
    s_cbranch_scc1 L_end
    s_add_u32 s36, s32, 524288
    s_add_u32 s37, s33, 524288
    s_add_u32 s38, s34, 524288
    s_add_u32 s39, s35, 524288
    s_mov_b32 s30, 131072
L_poll_f:
    buffer_load_dwordx4 v[48:51], v36, s[56:59], s32 offen offset:0 sc1
    buffer_load_dwordx4 v[52:55], v36, s[56:59], s33 offen offset:0 sc1
    buffer_load_dwordx4 v[56:59], v36, s[56:59], s34 offen offset:0 sc1
    buffer_load_dwordx4 v[60:63], v36, s[56:59], s35 offen offset:0 sc1
    buffer_load_dwordx4 v[64:67], v36, s[56:59], s36 offen offset:0 sc1
    buffer_load_dwordx4 v[68:71], v36, s[56:59], s37 offen offset:0 sc1
    buffer_load_dwordx4 v[72:75], v36, s[56:59], s38 offen offset:0 sc1
    buffer_load_dwordx4 v[76:79], v36, s[56:59], s39 offen offset:0 sc1
    s_waitcnt vmcnt(0)
    v_xor_b32 v38, v49, v24
    v_xor_b32 v39, v51, v24
    v_or_b32 v27, v38, v39
    v_xor_b32 v38, v53, v24
    v_xor_b32 v39, v55, v24
    v_or3_b32 v27, v38, v39, v27
    v_xor_b32 v38, v57, v24
    v_xor_b32 v39, v59, v24
    v_or3_b32 v27, v38, v39, v27
    v_xor_b32 v38, v61, v24
    v_xor_b32 v39, v63, v24
    v_or3_b32 v27, v38, v39, v27
    v_xor_b32 v38, v65, v24
    v_xor_b32 v39, v67, v24
    v_or3_b32 v27, v38, v39, v27
    v_xor_b32 v38, v69, v24
    v_xor_b32 v39, v71, v24
    v_or3_b32 v27, v38, v39, v27
    v_xor_b32 v38, v73, v24
    v_xor_b32 v39, v75, v24
    v_or3_b32 v27, v38, v39, v27
    v_xor_b32 v38, v77, v24
    v_xor_b32 v39, v79, v24
    v_or3_b32 v27, v38, v39, v27
    v_cmp_ne_u32 vcc, 0, v27
    s_cbranch_vccz L_polled_f
    s_sleep 1
    s_sub_u32 s30, s30, 1
    s_cmp_lg_u32 s30, 0
    s_cbranch_scc1 L_poll_f
L_polled_f:
    v_add_f32 v12, v48, v52
    v_add_f32 v13, v50, v54
    v_add_f32 v12, v12, v56
    v_add_f32 v13, v13, v58
    v_add_f32 v12, v12, v60
    v_add_f32 v13, v13, v62
    s_nop 0
    v_add_f32_dpp v12, v12, v12 row_ror:8 row_mask:0xf bank_mask:0xf
    v_add_f32_dpp v13, v13, v13 row_ror:8 row_mask:0xf bank_mask:0xf
    v_mov_b32 v38, v12
    v_mov_b32 v39, v13
    s_nop 0
    v_permlane16_swap_b32 v12, v38
    v_permlane16_swap_b32 v13, v39
    v_add_f32 v12, v12, v38
    v_add_f32 v13, v13, v39
    v_mov_b32 v38, v12
    v_mov_b32 v39, v13
    s_nop 0
    v_permlane32_swap_b32 v12, v38
    v_permlane32_swap_b32 v13, v39
    v_add_f32 v12, v12, v38
    v_add_f32 v13, v13, v39
    v_cvt_pk_bf16_f32 v12, v12, v12
    v_and_b32 v12, 0xffff0000, v12
    v_cvt_pk_bf16_f32 v13, v13, v13
    v_and_b32 v13, 0xffff0000, v13
    v_add_f32 v88, v64, v68
    v_add_f32 v89, v66, v70
    v_add_f32 v88, v88, v72
    v_add_f32 v89, v89, v74
    v_add_f32 v88, v88, v76
    v_add_f32 v89, v89, v78
    s_nop 0
    v_add_f32_dpp v88, v88, v88 row_ror:8 row_mask:0xf bank_mask:0xf
    v_add_f32_dpp v89, v89, v89 row_ror:8 row_mask:0xf bank_mask:0xf
    v_mov_b32 v38, v88
    v_mov_b32 v39, v89
    s_nop 0
    v_permlane16_swap_b32 v88, v38
    v_permlane16_swap_b32 v89, v39
    v_add_f32 v88, v88, v38
    v_add_f32 v89, v89, v39
    v_mov_b32 v38, v88
    v_mov_b32 v39, v89
    s_nop 0
    v_permlane32_swap_b32 v88, v38
    v_permlane32_swap_b32 v89, v39
    v_add_f32 v88, v88, v38
    v_add_f32 v89, v89, v39
    v_cvt_pk_bf16_f32 v88, v88, v88
    v_and_b32 v88, 0xffff0000, v88
    v_cvt_pk_bf16_f32 v89, v89, v89
    v_and_b32 v89, 0xffff0000, v89
L_t_fin:
    v_lshlrev_b32 v14, 16, v25
    v_and_b32 v15, 0xffff0000, v25
    v_add_f32 v12, v14, v12
    v_add_f32 v13, v15, v13
    v_cvt_pk_bf16_f32 v12, v12, v12
    v_and_b32 v12, 0xffff0000, v12
    v_cvt_pk_bf16_f32 v13, v13, v13
    v_and_b32 v13, 0xffff0000, v13
    v_add_f32 v12, v12, v88
    v_add_f32 v13, v13, v89
    v_cvt_pk_bf16_f32 v12, v12, v13
    v_lshrrev_b32 v38, 3, v0
    v_lshl_add_u32 v38, v38, 12, v30
    buffer_store_dword v12, v38, s[60:63], s64 offen
    s_cmp_lg_u32 s2, 0
    s_cbranch_scc1 L_hexit
    buffer_store_dword v24, v29, s[56:59], 0 offen sc1
L_hexit:
L_end:
    s_endpgm
.section .rodata,"a"
.p2align 6
.amdhsa_kernel parallel_sum__mha_block_cached__geglu_ffn__decode_kernel
  .amdhsa_next_free_vgpr 240
  .amdhsa_next_free_sgpr 96
  .amdhsa_accum_offset 240
  .amdhsa_group_segment_fixed_size 0
  .amdhsa_kernarg_size 96
  .amdhsa_user_sgpr_count 2
  .amdhsa_user_sgpr_kernarg_segment_ptr 1
  .amdhsa_system_sgpr_workgroup_id_x 1
  .amdhsa_float_denorm_mode_32 3
.end_amdhsa_kernel
```
